```python
import torch

def _softmax(x, axis=-1):
    return torch.softmax(x, dim=axis)
def _gelu(x):
    return torch.nn.functional.gelu(x, approximate="tanh")
def _silu(x):
    return torch.nn.functional.silu(x)
def _sigmoid(x):
    return torch.sigmoid(x)
def _layernorm(x, axis=-1, eps=1e-5):
    m = x.mean(dim=axis, keepdim=True)
    v = x.var(dim=axis, keepdim=True, unbiased=False)
    return (x - m) / torch.sqrt(v + eps)
def _scatter_add(tgt, idx, src, axis=0):
    return tgt.clone().index_add_(axis, idx, src)
def _segment_sum(src, seg, n):
    out = torch.zeros((n,) + src.shape[1:], dtype=src.dtype)
    return out.index_add_(0, seg, src)
def _pad(x, pw):
    flat = tuple(v for pair in reversed(pw) for v in pair)
    return torch.nn.functional.pad(x, flat)

kernel_name = 'recurrent_scan__sliding_block_cached__glu_gated_swiglu__decode'

def setup_inputs():

    _w = (lambda a: (lambda t: t.to(torch.bfloat16) if t.is_floating_point() else t)(torch.as_tensor(a)))
    def _A_setup():
        B, Sq, D = 2, 1, 576
        Hq, Hkv, Sk, Dh = 32, 16, 32768, 128
        assert Hq % Hkv == 0, (Hq, Hkv)
        return {
            "x": _w((lambda *s: torch.randn(*s, dtype=torch.bfloat16) * 0.05)(B, Sq, D)),
            "k_cache": _w((lambda *s: torch.randn(*s, dtype=torch.bfloat16) * 3.2)(B, Hkv, Sk, Dh)),
            "v_cache": _w((lambda *s: torch.randn(*s, dtype=torch.bfloat16) * 3.2)(B, Hkv, Sk, Dh)),
            "wq": _w((lambda *s: torch.randn(*s, dtype=torch.bfloat16) * 3.2)(D, Hq * Dh) * (D ** -0.5)),
            "wo": _w((lambda *s: torch.randn(*s, dtype=torch.bfloat16) * 3.2)(Hq * Dh, D) * ((Hq * Dh) ** -0.5)),
        }
    _A_in = _A_setup()

    def _B_setup():
        B, S, D, F = 2, 1, 576, 4608
        return {
            "x": _w((lambda *s: torch.randn(*s, dtype=torch.bfloat16) * 0.05)(B, S, D)),
            "w1": _w((lambda *s: torch.randn(*s, dtype=torch.bfloat16) * 0.4)(D, F) * (2.0 / D) ** 0.5),
            "w3": _w((lambda *s: torch.randn(*s, dtype=torch.bfloat16) * 0.4)(D, F) * (2.0 / D) ** 0.5),
            "w2": _w((lambda *s: torch.randn(*s, dtype=torch.bfloat16) * 0.4)(F, D) * (2.0 / F) ** 0.5),
        }
    _B_in = _B_setup()

    return {
        "A_x": _A_in["x"],
        "A_k_cache": _A_in["k_cache"],
        "A_v_cache": _A_in["v_cache"],
        "A_wq": _A_in["wq"],
        "A_wo": _A_in["wo"],
        "B_x": _B_in["x"],
        "B_w1": _B_in["w1"],
        "B_w3": _B_in["w3"],
        "B_w2": _B_in["w2"],
    }

def reference(A_x, A_k_cache, A_v_cache, A_wq, A_wo, B_x, B_w1, B_w3, B_w2):
    def _A_ref(x, k_cache, v_cache, wq, wo):
        B, Sq, D = x.shape
        Hq, Dh = 32, 128
        Hkv, Sk = k_cache.shape[1], k_cache.shape[2]
        W = min(4096, max(256, Sk // 4))
        rep = Hq // Hkv
        q = (lambda x, *d: x.permute(*d))((x @ wq).reshape(B, Sq, Hq, Dh), 0, 2, 1, 3)
        k = (lambda x, n, axis: torch.repeat_interleave(x, n, dim=axis))(k_cache[:, :, Sk - W:, :], rep, axis=1)
        v = (lambda x, n, axis: torch.repeat_interleave(x, n, dim=axis))(v_cache[:, :, Sk - W:, :], rep, axis=1)
        scores = torch.einsum("bhqd,bhkd->bhqk", q, k) * (Dh ** -0.5)
        p = _softmax(scores, axis=-1)
        o = torch.einsum("bhqk,bhkd->bhqd", p, v)
        return (lambda x, *d: x.permute(*d))(o, 0, 2, 1, 3).reshape(B, Sq, Hq * Dh) @ wo

    def _B_ref(x, w1, w3, w2):
        gate = torch.einsum("bsd,df->bsf", x, w1)
        up = torch.einsum("bsd,df->bsf", x, w3)
        h = _silu(gate) * up
        out = torch.einsum("bsf,fd->bsd", h, w2)
        return out

    x = A_x
    xn = _layernorm(x, axis=-1)
    s = _A_ref(xn, A_k_cache, A_v_cache, A_wq, A_wo)
    g = _silu(_B_ref(xn, B_w1, B_w3, B_w2))
    return x + s * g
```

```asm
; @launch grid=(256,1,1) block=(768,1,1) lds=161024
.amdgcn_target "amdgcn-amd-amdhsa--gfx950"
.text
.globl recurrent_scan__sliding_block_cached__glu_gated_swiglu__decode_kernel
.p2align 8
.type recurrent_scan__sliding_block_cached__glu_gated_swiglu__decode_kernel,@function
recurrent_scan__sliding_block_cached__glu_gated_swiglu__decode_kernel:
    s_cmp_ge_u32 s2, 256
    s_cbranch_scc1 L_end
    s_load_dwordx16 s[4:19], s[0:1], 0
    s_load_dwordx8 s[20:27], s[0:1], 64
    v_lshrrev_b32 v2, 6, v0
    v_and_b32 v1, 63, v0
    v_readfirstlane_b32 s3, v2
    s_getpc_b64 s[28:29]
L_pc:
    s_add_u32 s28, s28, L_roles-L_pc
    s_addc_u32 s29, s29, 0
    s_lshl_b32 s30, s2, 2
    s_load_dword s101, s[28:29], s30
    v_and_b32 v3, 7, v1
    v_and_b32 v4, 1, v3
    v_lshlrev_b32 v4, 4, v4
    v_mov_b32 v5, 0xffff
    v_lshlrev_b32 v4, v4, v5
    v_lshrrev_b32 v3, 1, v3
    v_cmp_eq_u32 vcc, 0, v3
    s_nop 1
    v_cndmask_b32 v12, 0, v4, vcc
    v_cmp_eq_u32 vcc, 1, v3
    s_nop 1
    v_cndmask_b32 v13, 0, v4, vcc
    v_cmp_eq_u32 vcc, 2, v3
    s_nop 1
    v_cndmask_b32 v14, 0, v4, vcc
    v_cmp_eq_u32 vcc, 3, v3
    s_nop 1
    v_cndmask_b32 v15, 0, v4, vcc
    v_mov_b32 v10, 160896
    v_mov_b32 v11, 1
    s_mov_b32 s40, 0x7060500
    s_mov_b32 s41, 0x7060501
    s_mov_b32 s42, 0x7060502
    s_mov_b32 s43, 0x7060503
    s_mov_b32 s44, 0x0c0c0400
    s_mov_b32 s45, 0x04000c0c
    s_mov_b32 s46, 0xffffff00
    s_cmp_lg_u32 s3, 0
    s_cbranch_scc1 L_noinit_1
    v_lshlrev_b32 v3, 2, v1
    v_add_u32 v3, 160896, v3
    v_mov_b32 v4, 0
    s_mov_b32 exec_lo, 0xffff
    s_mov_b32 exec_hi, 0x0
    ds_write_b32 v3, v4
    s_mov_b64 exec, -1
L_noinit_1:
    s_cmp_ge_u32 s3, 8
    s_cbranch_scc1 L_wts
    s_setprio 2
    v_lshrrev_b32 v20, 4, v1
    v_and_b32 v21, 15, v1
    v_lshlrev_b32 v22, 2, v20
    v_lshlrev_b32 v23, 8, v20
    v_add_u32 v24, 0, v22
    v_xor_b32 v24, v24, v21
    v_lshl_add_u32 v2, v24, 4, v23
    v_add_u32 v24, 1, v22
    v_xor_b32 v24, v24, v21
    v_lshl_add_u32 v3, v24, 4, v23
    v_add_u32 v24, 2, v22
    v_xor_b32 v24, v24, v21
    v_lshl_add_u32 v4, v24, 4, v23
    v_add_u32 v24, 3, v22
    v_xor_b32 v24, v24, v21
    v_lshl_add_u32 v5, v24, 4, v23
    v_lshlrev_b32 v6, 4, v1
    v_lshrrev_b32 v22, 2, v21
    v_and_b32 v23, 3, v21
    v_lshl_add_u32 v24, v23, 2, v22
    v_lshlrev_b32 v24, 8, v24
    v_xor_b32 v25, v23, v20
    s_lshl_b32 s28, s3, 14
    v_add_u32 v24, s28, v24
    v_lshl_add_u32 v24, v25, 4, v24
    v_xor_b32 v26, 0, v22
    v_lshl_add_u32 v7, v26, 6, v24
    v_xor_b32 v26, 1, v22
    v_lshl_add_u32 v8, v26, 6, v24
    v_xor_b32 v26, 2, v22
    v_lshl_add_u32 v9, v26, 6, v24
    v_xor_b32 v26, 3, v22
    v_lshl_add_u32 v18, v26, 6, v24
    v_lshrrev_b32 v22, 3, v1
    v_and_b32 v22, 1, v22
    v_lshlrev_b32 v22, 8, v22
    v_lshl_add_u32 v19, v20, 4, v22
    v_add_u32 v19, 135680, v19
    v_mov_b32 v160, 0
    s_waitcnt lgkmcnt(0)
    s_and_b32 s96, s101, 0xff
    s_bfe_u32 s97, s101, 0x80008
    s_bfe_u32 s98, s101, 0x80010
    s_lshr_b32 s101, s101, 24
    s_lshr_b32 s28, s96, 3
    s_and_b32 s29, s96, 7
    s_lshl_b32 s28, s28, 23
    s_lshl_b32 s29, s29, 17
    s_add_u32 s28, s28, s29
    s_add_u32 s28, s28, 0x700000
    s_mul_i32 s31, s96, 1
    s_add_u32 s31, s31, s3
    s_add_u32 s6, s6, s28
    s_addc_u32 s7, s7, 0
    s_add_u32 s8, s8, s28
    s_addc_u32 s9, s9, 0
    s_lshl_b32 s37, s3, 14
    global_load_dword v16, v160, s[26:27] sc1
    s_add_u32 s32, s31, 0
    s_and_b32 s32, s32, 31
    s_lshl_b32 s32, s32, 12
    s_add_u32 s34, s6, s32
    s_addc_u32 s35, s7, 0
    s_add_u32 s33, s37, 0
    s_mov_b32 m0, s33
    s_nop 0
    global_load_lds_dwordx4 v2, s[34:35] offset:0 nt
    global_load_lds_dwordx4 v3, s[34:35] offset:1024 nt
    global_load_lds_dwordx4 v4, s[34:35] offset:2048 nt
    global_load_lds_dwordx4 v5, s[34:35] offset:3072 nt
    s_add_u32 s32, s31, 8
    s_and_b32 s32, s32, 31
    s_lshl_b32 s32, s32, 12
    s_add_u32 s34, s6, s32
    s_addc_u32 s35, s7, 0
    s_add_u32 s33, s37, 4096
    s_mov_b32 m0, s33
    s_nop 0
    global_load_lds_dwordx4 v2, s[34:35] offset:0 nt
    global_load_lds_dwordx4 v3, s[34:35] offset:1024 nt
    s_waitcnt lgkmcnt(0)
    s_barrier
    s_waitcnt vmcnt(5)
    global_load_lds_dwordx4 v4, s[34:35] offset:2048 nt
    s_waitcnt vmcnt(5)
    global_load_lds_dwordx4 v5, s[34:35] offset:3072 nt
    s_waitcnt vmcnt(5)
    s_add_u32 s32, s31, 16
    s_and_b32 s32, s32, 31
    s_lshl_b32 s32, s32, 12
    s_add_u32 s34, s6, s32
    s_addc_u32 s35, s7, 0
    s_add_u32 s33, s37, 8192
    s_mov_b32 m0, s33
    s_nop 0
    global_load_lds_dwordx4 v2, s[34:35] offset:0 nt
    s_waitcnt vmcnt(5)
    global_load_lds_dwordx4 v3, s[34:35] offset:1024 nt
    s_waitcnt vmcnt(5)
    global_load_lds_dwordx4 v4, s[34:35] offset:2048 nt
    s_waitcnt vmcnt(5)
    global_load_lds_dwordx4 v5, s[34:35] offset:3072 nt
    s_waitcnt vmcnt(5)
    s_add_u32 s32, s31, 24
    s_and_b32 s32, s32, 31
    s_lshl_b32 s32, s32, 12
    s_add_u32 s34, s6, s32
    s_addc_u32 s35, s7, 0
    s_add_u32 s33, s37, 12288
    s_mov_b32 m0, s33
    s_nop 0
    global_load_lds_dwordx4 v2, s[34:35] offset:0 nt
    s_waitcnt vmcnt(5)
    global_load_lds_dwordx4 v3, s[34:35] offset:1024 nt
    s_waitcnt vmcnt(5)
    global_load_lds_dwordx4 v4, s[34:35] offset:2048 nt
    s_waitcnt vmcnt(5)
    global_load_lds_dwordx4 v5, s[34:35] offset:3072 nt
    s_setprio 1
    s_waitcnt vmcnt(5)
    s_add_u32 s32, s31, 0
    s_and_b32 s32, s32, 31
    s_lshl_b32 s32, s32, 12
    s_add_u32 s38, s8, s32
    s_addc_u32 s39, s9, 0
    global_load_dwordx4 v[96:99], v6, s[38:39] offset:0 nt
    s_waitcnt vmcnt(5)
    global_load_dwordx4 v[100:103], v6, s[38:39] offset:1024 nt
    s_waitcnt vmcnt(5)
    global_load_dwordx4 v[104:107], v6, s[38:39] offset:2048 nt
    s_waitcnt vmcnt(5)
    global_load_dwordx4 v[108:111], v6, s[38:39] offset:3072 nt
    s_waitcnt vmcnt(5)
    s_add_u32 s32, s31, 8
    s_and_b32 s32, s32, 31
    s_lshl_b32 s32, s32, 12
    s_add_u32 s38, s8, s32
    s_addc_u32 s39, s9, 0
    global_load_dwordx4 v[112:115], v6, s[38:39] offset:0 nt
    s_waitcnt vmcnt(5)
    global_load_dwordx4 v[116:119], v6, s[38:39] offset:1024 nt
    s_waitcnt vmcnt(6)
    global_load_dwordx4 v[120:123], v6, s[38:39] offset:2048 nt
    global_load_dwordx4 v[124:127], v6, s[38:39] offset:3072 nt
    v_add_u32 v16, 1, v16
    s_mov_b32 s28, 0x9E3779B1
    v_mul_lo_u32 v17, v16, s28
    v_not_b32 v160, v17
    v_and_b32 v160, 1, v160
    v_lshlrev_b32 v160, 8, v160
    v_and_b32 v17, 0xfffffeff, v17
    v_or_b32 v17, v17, v160
    s_mov_b32 s30, 0
L_spin_2:
    ds_read_b32 v160, v10 offset:8
    s_waitcnt lgkmcnt(0)
    v_readfirstlane_b32 s29, v160
    s_nop 0
    s_cmp_ge_u32 s29, 4
    s_cbranch_scc1 L_spind_3
    s_add_u32 s30, s30, 1
    s_cmp_lt_u32 s30, 1048576
    s_cbranch_scc1 L_spin_2
L_spind_3:
    ds_read_b128 v[20:23], v19 offset:0
    ds_read_b128 v[24:27], v19 offset:64
    ds_read_b128 v[28:31], v19 offset:128
    ds_read_b128 v[32:35], v19 offset:192
    ds_read_b128 v[52:55], v7 offset:0
    ds_read_b128 v[56:59], v8 offset:0
    ds_read_b128 v[60:63], v9 offset:0
    ds_read_b128 v[64:67], v18 offset:0
    ds_read_b128 v[68:71], v7 offset:4096
    ds_read_b128 v[72:75], v8 offset:4096
    ds_read_b128 v[76:79], v9 offset:4096
    ds_read_b128 v[80:83], v18 offset:4096
    s_waitcnt lgkmcnt(4)
    v_mfma_f32_16x16x32_bf16 v[36:39], v[52:55], v[20:23], 0
    v_mfma_f32_16x16x32_bf16 v[36:39], v[56:59], v[24:27], v[36:39]
    v_mfma_f32_16x16x32_bf16 v[36:39], v[60:63], v[28:31], v[36:39]
    v_mfma_f32_16x16x32_bf16 v[36:39], v[64:67], v[32:35], v[36:39]
    ds_read_b128 v[52:55], v7 offset:8192
    ds_read_b128 v[56:59], v8 offset:8192
    ds_read_b128 v[60:63], v9 offset:8192
    ds_read_b128 v[64:67], v18 offset:8192
    s_waitcnt lgkmcnt(4)
    v_mfma_f32_16x16x32_bf16 v[40:43], v[68:71], v[20:23], 0
    v_mfma_f32_16x16x32_bf16 v[40:43], v[72:75], v[24:27], v[40:43]
    v_mfma_f32_16x16x32_bf16 v[40:43], v[76:79], v[28:31], v[40:43]
    v_mfma_f32_16x16x32_bf16 v[40:43], v[80:83], v[32:35], v[40:43]
    ds_read_b128 v[68:71], v7 offset:12288
    ds_read_b128 v[72:75], v8 offset:12288
    ds_read_b128 v[76:79], v9 offset:12288
    ds_read_b128 v[80:83], v18 offset:12288
    s_waitcnt lgkmcnt(4)
    v_mfma_f32_16x16x32_bf16 v[44:47], v[52:55], v[20:23], 0
    v_mfma_f32_16x16x32_bf16 v[44:47], v[56:59], v[24:27], v[44:47]
    v_mfma_f32_16x16x32_bf16 v[44:47], v[60:63], v[28:31], v[44:47]
    v_mfma_f32_16x16x32_bf16 v[44:47], v[64:67], v[32:35], v[44:47]
    s_waitcnt lgkmcnt(0)
    v_mfma_f32_16x16x32_bf16 v[48:51], v[68:71], v[20:23], 0
    v_mfma_f32_16x16x32_bf16 v[48:51], v[72:75], v[24:27], v[48:51]
    v_mfma_f32_16x16x32_bf16 v[48:51], v[76:79], v[28:31], v[48:51]
    v_mfma_f32_16x16x32_bf16 v[48:51], v[80:83], v[32:35], v[48:51]
    s_mov_b32 s47, 0x3db504f3
    v_cvt_pk_bf16_f32 v160, v36, v37
    v_lshlrev_b32 v36, 16, v160
    v_and_b32 v37, 0xffff0000, v160
    v_mul_f32 v36, s47, v36
    v_mul_f32 v37, s47, v37
    v_cvt_pk_bf16_f32 v161, v36, v37
    v_lshlrev_b32 v36, 16, v161
    v_and_b32 v37, 0xffff0000, v161
    v_cvt_pk_bf16_f32 v162, v38, v39
    v_lshlrev_b32 v38, 16, v162
    v_and_b32 v39, 0xffff0000, v162
    v_mul_f32 v38, s47, v38
    v_mul_f32 v39, s47, v39
    v_cvt_pk_bf16_f32 v163, v38, v39
    v_lshlrev_b32 v38, 16, v163
    v_and_b32 v39, 0xffff0000, v163
    v_cvt_pk_bf16_f32 v160, v40, v41
    v_lshlrev_b32 v40, 16, v160
    v_and_b32 v41, 0xffff0000, v160
    v_mul_f32 v40, s47, v40
    v_mul_f32 v41, s47, v41
    v_cvt_pk_bf16_f32 v161, v40, v41
    v_lshlrev_b32 v40, 16, v161
    v_and_b32 v41, 0xffff0000, v161
    v_cvt_pk_bf16_f32 v162, v42, v43
    v_lshlrev_b32 v42, 16, v162
    v_and_b32 v43, 0xffff0000, v162
    v_mul_f32 v42, s47, v42
    v_mul_f32 v43, s47, v43
    v_cvt_pk_bf16_f32 v163, v42, v43
    v_lshlrev_b32 v42, 16, v163
    v_and_b32 v43, 0xffff0000, v163
    v_cvt_pk_bf16_f32 v160, v44, v45
    v_lshlrev_b32 v44, 16, v160
    v_and_b32 v45, 0xffff0000, v160
    v_mul_f32 v44, s47, v44
    v_mul_f32 v45, s47, v45
    v_cvt_pk_bf16_f32 v161, v44, v45
    v_lshlrev_b32 v44, 16, v161
    v_and_b32 v45, 0xffff0000, v161
    v_cvt_pk_bf16_f32 v162, v46, v47
    v_lshlrev_b32 v46, 16, v162
    v_and_b32 v47, 0xffff0000, v162
    v_mul_f32 v46, s47, v46
    v_mul_f32 v47, s47, v47
    v_cvt_pk_bf16_f32 v163, v46, v47
    v_lshlrev_b32 v46, 16, v163
    v_and_b32 v47, 0xffff0000, v163
    v_cvt_pk_bf16_f32 v160, v48, v49
    v_lshlrev_b32 v48, 16, v160
    v_and_b32 v49, 0xffff0000, v160
    v_mul_f32 v48, s47, v48
    v_mul_f32 v49, s47, v49
    v_cvt_pk_bf16_f32 v161, v48, v49
    v_lshlrev_b32 v48, 16, v161
    v_and_b32 v49, 0xffff0000, v161
    v_cvt_pk_bf16_f32 v162, v50, v51
    v_lshlrev_b32 v50, 16, v162
    v_and_b32 v51, 0xffff0000, v162
    v_mul_f32 v50, s47, v50
    v_mul_f32 v51, s47, v51
    v_cvt_pk_bf16_f32 v163, v50, v51
    v_lshlrev_b32 v50, 16, v163
    v_and_b32 v51, 0xffff0000, v163
    v_max3_f32 v160, v36, v37, v38
    v_max3_f32 v161, v39, v40, v41
    v_max3_f32 v162, v42, v43, v44
    v_max3_f32 v163, v45, v46, v47
    v_max3_f32 v160, v160, v48, v49
    v_max3_f32 v161, v161, v50, v51
    v_max3_f32 v160, v160, v161, v162
    v_max_f32 v160, v160, v163
    v_mov_b32 v161, v160
    s_nop 1
    v_permlane16_swap_b32 v160, v161
    v_max_f32 v160, v160, v161
    v_mov_b32 v161, v160
    s_nop 1
    v_permlane32_swap_b32 v160, v161
    v_max_f32 v160, v160, v161
    v_mov_b32 v22, v160
    v_lshrrev_b32 v20, 3, v1
    v_and_b32 v20, 1, v20
    v_lshlrev_b32 v20, 5, v20
    v_add_u32 v20, 160768, v20
    s_lshl_b32 s28, s3, 2
    v_add_u32 v21, s28, v20
    s_mov_b32 s48, 0x3fb8aa3b
    v_mul_f32 v23, s48, v22
    v_fma_f32 v36, v36, s48, -v23
    v_fma_f32 v37, v37, s48, -v23
    v_fma_f32 v38, v38, s48, -v23
    v_fma_f32 v39, v39, s48, -v23
    v_fma_f32 v40, v40, s48, -v23
    v_fma_f32 v41, v41, s48, -v23
    v_fma_f32 v42, v42, s48, -v23
    v_fma_f32 v43, v43, s48, -v23
    v_fma_f32 v44, v44, s48, -v23
    v_fma_f32 v45, v45, s48, -v23
    v_fma_f32 v46, v46, s48, -v23
    v_fma_f32 v47, v47, s48, -v23
    v_fma_f32 v48, v48, s48, -v23
    v_fma_f32 v49, v49, s48, -v23
    v_fma_f32 v50, v50, s48, -v23
    v_fma_f32 v51, v51, s48, -v23
    v_exp_f32 v36, v36
    v_exp_f32 v37, v37
    v_exp_f32 v38, v38
    v_exp_f32 v39, v39
    v_exp_f32 v40, v40
    v_exp_f32 v41, v41
    v_exp_f32 v42, v42
    v_exp_f32 v43, v43
    v_exp_f32 v44, v44
    v_exp_f32 v45, v45
    v_exp_f32 v46, v46
    v_exp_f32 v47, v47
    v_exp_f32 v48, v48
    v_exp_f32 v49, v49
    v_exp_f32 v50, v50
    v_exp_f32 v51, v51
    v_add_f32 v24, v36, v37
    v_add_f32 v25, v38, v39
    v_add_f32 v24, v24, v40
    v_add_f32 v24, v24, v41
    v_add_f32 v25, v25, v42
    v_add_f32 v25, v25, v43
    v_add_f32 v24, v24, v44
    v_add_f32 v24, v24, v45
    v_add_f32 v25, v25, v46
    v_add_f32 v25, v25, v47
    v_add_f32 v24, v24, v48
    v_add_f32 v24, v24, v49
    v_add_f32 v25, v25, v50
    v_add_f32 v25, v25, v51
    v_add_f32 v24, v24, v25
    v_cvt_pk_bf16_f32 v36, v36, v36
    v_cvt_pk_bf16_f32 v37, v37, v37
    v_cvt_pk_bf16_f32 v38, v38, v38
    v_cvt_pk_bf16_f32 v39, v39, v39
    v_cvt_pk_bf16_f32 v40, v40, v40
    v_cvt_pk_bf16_f32 v41, v41, v41
    v_cvt_pk_bf16_f32 v42, v42, v42
    v_cvt_pk_bf16_f32 v43, v43, v43
    v_cvt_pk_bf16_f32 v44, v44, v44
    v_cvt_pk_bf16_f32 v45, v45, v45
    v_cvt_pk_bf16_f32 v46, v46, v46
    v_cvt_pk_bf16_f32 v47, v47, v47
    v_cvt_pk_bf16_f32 v48, v48, v48
    v_cvt_pk_bf16_f32 v49, v49, v49
    v_cvt_pk_bf16_f32 v50, v50, v50
    v_cvt_pk_bf16_f32 v51, v51, v51
    v_and_b32 v88, v36, v12
    v_and_b32 v89, v36, v13
    v_and_b32 v90, v36, v14
    v_and_b32 v91, v36, v15
    s_waitcnt vmcnt(7)
    s_nop 0
    v_mfma_f32_16x16x32_bf16 v[84:87], v[96:99], v[88:91], 0
    v_and_b32 v92, v37, v12
    v_and_b32 v93, v37, v13
    v_and_b32 v94, v37, v14
    v_and_b32 v95, v37, v15
    s_waitcnt vmcnt(6)
    s_nop 0
    v_mfma_f32_16x16x32_bf16 v[84:87], v[100:103], v[92:95], v[84:87]
    v_and_b32 v88, v38, v12
    v_and_b32 v89, v38, v13
    v_and_b32 v90, v38, v14
    v_and_b32 v91, v38, v15
    s_waitcnt vmcnt(5)
    s_nop 0
    v_mfma_f32_16x16x32_bf16 v[84:87], v[104:107], v[88:91], v[84:87]
    s_add_u32 s32, s31, 16
    s_and_b32 s32, s32, 31
    s_lshl_b32 s32, s32, 12
    s_add_u32 s38, s8, s32
    s_addc_u32 s39, s9, 0
    global_load_dwordx4 v[128:131], v6, s[38:39] offset:0 nt
    s_setprio 0
    v_and_b32 v92, v39, v12
    v_and_b32 v93, v39, v13
    v_and_b32 v94, v39, v14
    v_and_b32 v95, v39, v15
    s_waitcnt vmcnt(5)
    s_nop 0
    v_mfma_f32_16x16x32_bf16 v[84:87], v[108:111], v[92:95], v[84:87]
    global_load_dwordx4 v[132:135], v6, s[38:39] offset:1024 nt
    v_mov_b32 v25, v24
    s_nop 1
    v_permlane16_swap_b32 v24, v25
    v_add_f32 v24, v24, v25
    v_mov_b32 v25, v24
    s_nop 1
    v_permlane32_swap_b32 v24, v25
    v_add_f32 v24, v24, v25
    s_mov_b32 exec_lo, 0x101
    s_mov_b32 exec_hi, 0x0
    ds_write_b32 v21, v22
    ds_write_b32 v21, v24 offset:64
    s_mov_b64 exec, -1
    s_mov_b64 exec, 1
    ds_add_rtn_u32 v161, v10, v11 offset:16
    s_waitcnt lgkmcnt(0)
    v_readfirstlane_b32 s49, v161
    s_mov_b64 exec, -1
    s_cmp_lg_u32 s49, 7
    s_cbranch_scc1 L_noml_4
    ds_read_b128 v[52:55], v20
    ds_read_b128 v[56:59], v20 offset:16
    ds_read_b128 v[60:63], v20 offset:64
    ds_read_b128 v[64:67], v20 offset:80
    s_waitcnt lgkmcnt(0)
    v_max3_f32 v26, v52, v53, v54
    v_max3_f32 v27, v55, v56, v57
    v_max3_f32 v26, v26, v58, v59
    v_max_f32 v26, v26, v27
    v_sub_f32 v52, v52, v26
    v_sub_f32 v53, v53, v26
    v_sub_f32 v54, v54, v26
    v_sub_f32 v55, v55, v26
    v_sub_f32 v56, v56, v26
    v_sub_f32 v57, v57, v26
    v_sub_f32 v58, v58, v26
    v_sub_f32 v59, v59, v26
    v_mul_f32 v52, s48, v52
    v_mul_f32 v53, s48, v53
    v_mul_f32 v54, s48, v54
    v_mul_f32 v55, s48, v55
    v_mul_f32 v56, s48, v56
    v_mul_f32 v57, s48, v57
    v_mul_f32 v58, s48, v58
    v_mul_f32 v59, s48, v59
    v_exp_f32 v52, v52
    v_exp_f32 v53, v53
    v_exp_f32 v54, v54
    v_exp_f32 v55, v55
    v_exp_f32 v56, v56
    v_exp_f32 v57, v57
    v_exp_f32 v58, v58
    v_exp_f32 v59, v59
    v_mul_f32 v52, v52, v60
    v_mul_f32 v53, v53, v61
    v_mul_f32 v54, v54, v62
    v_mul_f32 v55, v55, v63
    v_mul_f32 v56, v56, v64
    v_mul_f32 v57, v57, v65
    v_mul_f32 v58, v58, v66
    v_mul_f32 v59, v59, v67
    v_add_f32 v52, v52, v53
    v_add_f32 v54, v54, v55
    v_add_f32 v56, v56, v57
    v_add_f32 v58, v58, v59
    v_add_f32 v52, v52, v54
    v_add_f32 v56, v56, v58
    v_add_f32 v53, v52, v56
    s_getreg_b32 s50, hwreg(HW_REG_XCC_ID, 0, 4)
    s_lshl_b32 s50, s50, 8
    v_mov_b32 v52, v26
    v_mov_b32 v54, s50
    v_mov_b32 v55, 0
    v_perm_b32 v52, v52, v17, s40
    v_perm_b32 v53, v53, v17, s41
    v_perm_b32 v54, v54, v17, s42
    v_perm_b32 v55, v55, v17, s43
    s_lshr_b32 s28, s96, 3
    s_and_b32 s29, s28, 15
    s_lshr_b32 s28, s28, 4
    s_lshl_b32 s29, s29, 9
    s_lshl_b32 s28, s28, 7
    s_add_u32 s28, s28, s29
    s_and_b32 s29, s96, 7
    s_lshl_b32 s29, s29, 4
    s_add_u32 s28, s28, s29
    s_add_u32 s28, s28, 655360
    v_lshrrev_b32 v27, 3, v1
    v_and_b32 v27, 1, v27
    v_lshlrev_b32 v27, 8, v27
    v_add_u32 v27, s28, v27
    s_mov_b32 exec_lo, 0x101
    s_mov_b32 exec_hi, 0x0
    global_store_dwordx4 v27, v[52:55], s[26:27] sc1
    s_mov_b64 exec, -1
L_noml_4:
    v_and_b32 v88, v40, v12
    v_and_b32 v89, v40, v13
    v_and_b32 v90, v40, v14
    v_and_b32 v91, v40, v15
    s_waitcnt vmcnt(5)
    s_nop 0
    v_mfma_f32_16x16x32_bf16 v[84:87], v[112:115], v[88:91], v[84:87]
    global_load_dwordx4 v[136:139], v6, s[38:39] offset:2048 nt
    v_and_b32 v92, v41, v12
    v_and_b32 v93, v41, v13
    v_and_b32 v94, v41, v14
    v_and_b32 v95, v41, v15
    s_waitcnt vmcnt(5)
    s_nop 0
    v_mfma_f32_16x16x32_bf16 v[84:87], v[116:119], v[92:95], v[84:87]
    global_load_dwordx4 v[140:143], v6, s[38:39] offset:3072 nt
    v_and_b32 v88, v42, v12
    v_and_b32 v89, v42, v13
    v_and_b32 v90, v42, v14
    v_and_b32 v91, v42, v15
    s_waitcnt vmcnt(5)
    s_nop 0
    v_mfma_f32_16x16x32_bf16 v[84:87], v[120:123], v[88:91], v[84:87]
    s_add_u32 s32, s31, 24
    s_and_b32 s32, s32, 31
    s_lshl_b32 s32, s32, 12
    s_add_u32 s38, s8, s32
    s_addc_u32 s39, s9, 0
    global_load_dwordx4 v[144:147], v6, s[38:39] offset:0 nt
    v_and_b32 v92, v43, v12
    v_and_b32 v93, v43, v13
    v_and_b32 v94, v43, v14
    v_and_b32 v95, v43, v15
    s_waitcnt vmcnt(5)
    s_nop 0
    v_mfma_f32_16x16x32_bf16 v[84:87], v[124:127], v[92:95], v[84:87]
    global_load_dwordx4 v[148:151], v6, s[38:39] offset:1024 nt
    v_and_b32 v88, v44, v12
    v_and_b32 v89, v44, v13
    v_and_b32 v90, v44, v14
    v_and_b32 v91, v44, v15
    s_waitcnt vmcnt(5)
    s_nop 0
    v_mfma_f32_16x16x32_bf16 v[84:87], v[128:131], v[88:91], v[84:87]
    global_load_dwordx4 v[152:155], v6, s[38:39] offset:2048 nt
    v_and_b32 v92, v45, v12
    v_and_b32 v93, v45, v13
    v_and_b32 v94, v45, v14
    v_and_b32 v95, v45, v15
    s_waitcnt vmcnt(5)
    s_nop 0
    v_mfma_f32_16x16x32_bf16 v[84:87], v[132:135], v[92:95], v[84:87]
    global_load_dwordx4 v[156:159], v6, s[38:39] offset:3072 nt
    s_mov_b64 exec, 1
    ds_add_u32 v10, v11 offset:20
    s_mov_b64 exec, -1
    s_mov_b32 s30, 0
L_spin_5:
    ds_read_b32 v160, v10 offset:16
    s_waitcnt lgkmcnt(0)
    v_readfirstlane_b32 s29, v160
    s_nop 0
    s_cmp_ge_u32 s29, 8
    s_cbranch_scc1 L_spind_6
    s_add_u32 s30, s30, 1
    s_cmp_lt_u32 s30, 1048576
    s_cbranch_scc1 L_spin_5
L_spind_6:
    ds_read_b128 v[52:55], v20
    ds_read_b128 v[56:59], v20 offset:16
    v_lshrrev_b32 v28, 4, v1
    v_lshlrev_b32 v28, 7, v28
    v_lshrrev_b32 v29, 3, v1
    v_and_b32 v29, 1, v29
    v_lshl_add_u32 v28, v29, 9, v28
    v_and_b32 v29, 7, v1
    v_lshl_add_u32 v28, v29, 4, v28
    s_lshl_b32 s28, s96, 10
    s_add_u32 s28, s28, 720896
    v_add_u32 v28, s28, v28
    s_lshl_b32 s28, s3, 10
    s_add_u32 s28, s28, 16384
    v_add_u32 v29, s28, v6
    v_add_u32 v30, 16384, v6
    v_add_u32 v31, 851968, v28
    s_waitcnt lgkmcnt(0)
    v_max3_f32 v26, v52, v53, v54
    v_max3_f32 v27, v55, v56, v57
    v_max3_f32 v26, v26, v58, v59
    v_max_f32 v26, v26, v27
    v_sub_f32 v26, v22, v26
    v_mul_f32 v26, s48, v26
    v_exp_f32 v26, v26
    s_setprio 3
    v_and_b32 v88, v46, v12
    v_and_b32 v89, v46, v13
    v_and_b32 v90, v46, v14
    v_and_b32 v91, v46, v15
    s_waitcnt vmcnt(5)
    s_nop 0
    v_mfma_f32_16x16x32_bf16 v[84:87], v[136:139], v[88:91], v[84:87]
    v_and_b32 v92, v47, v12
    v_and_b32 v93, v47, v13
    v_and_b32 v94, v47, v14
    v_and_b32 v95, v47, v15
    s_waitcnt vmcnt(4)
    s_nop 0
    v_mfma_f32_16x16x32_bf16 v[84:87], v[140:143], v[92:95], v[84:87]
    v_and_b32 v88, v48, v12
    v_and_b32 v89, v48, v13
    v_and_b32 v90, v48, v14
    v_and_b32 v91, v48, v15
    s_waitcnt vmcnt(3)
    s_nop 0
    v_mfma_f32_16x16x32_bf16 v[84:87], v[144:147], v[88:91], v[84:87]
    v_and_b32 v92, v49, v12
    v_and_b32 v93, v49, v13
    v_and_b32 v94, v49, v14
    v_and_b32 v95, v49, v15
    s_waitcnt vmcnt(2)
    s_nop 0
    v_mfma_f32_16x16x32_bf16 v[84:87], v[148:151], v[92:95], v[84:87]
    v_and_b32 v88, v50, v12
    v_and_b32 v89, v50, v13
    v_and_b32 v90, v50, v14
    v_and_b32 v91, v50, v15
    s_waitcnt vmcnt(1)
    s_nop 0
    v_mfma_f32_16x16x32_bf16 v[84:87], v[152:155], v[88:91], v[84:87]
    v_and_b32 v92, v51, v12
    v_and_b32 v93, v51, v13
    v_and_b32 v94, v51, v14
    v_and_b32 v95, v51, v15
    s_waitcnt vmcnt(0)
    s_nop 0
    v_mfma_f32_16x16x32_bf16 v[84:87], v[156:159], v[92:95], v[84:87]
    s_nop 7
    v_mul_f32 v84, v84, v26
    v_mul_f32 v85, v85, v26
    v_mul_f32 v86, v86, v26
    v_mul_f32 v87, v87, v26
    ds_write_b128 v29, v[84:87]
    s_mov_b64 exec, 1
    ds_add_rtn_u32 v160, v10, v11 offset:24
    s_waitcnt lgkmcnt(0)
    v_readfirstlane_b32 s49, v160
    s_mov_b64 exec, -1
    s_cmp_lg_u32 s49, 7
    s_cbranch_scc1 L_att_done
    ds_read_b128 v[52:55], v30 offset:0
    ds_read_b128 v[56:59], v30 offset:1024
    ds_read_b128 v[60:63], v30 offset:2048
    ds_read_b128 v[64:67], v30 offset:3072
    ds_read_b128 v[68:71], v30 offset:4096
    ds_read_b128 v[72:75], v30 offset:5120
    ds_read_b128 v[76:79], v30 offset:6144
    ds_read_b128 v[80:83], v30 offset:7168
    s_waitcnt lgkmcnt(6)
    v_pk_add_f32 v[52:53], v[52:53], v[56:57]
    v_pk_add_f32 v[54:55], v[54:55], v[58:59]
    s_waitcnt lgkmcnt(4)
    v_pk_add_f32 v[60:61], v[60:61], v[64:65]
    v_pk_add_f32 v[62:63], v[62:63], v[66:67]
    s_waitcnt lgkmcnt(2)
    v_pk_add_f32 v[68:69], v[68:69], v[72:73]
    v_pk_add_f32 v[70:71], v[70:71], v[74:75]
    v_pk_add_f32 v[52:53], v[52:53], v[60:61]
    v_pk_add_f32 v[54:55], v[54:55], v[62:63]
    s_waitcnt lgkmcnt(0)
    v_pk_add_f32 v[76:77], v[76:77], v[80:81]
    v_pk_add_f32 v[78:79], v[78:79], v[82:83]
    v_pk_add_f32 v[68:69], v[68:69], v[76:77]
    v_pk_add_f32 v[70:71], v[70:71], v[78:79]
    v_pk_add_f32 v[52:53], v[52:53], v[68:69]
    v_pk_add_f32 v[54:55], v[54:55], v[70:71]
    v_perm_b32 v52, v52, v17, s40
    v_perm_b32 v53, v53, v17, s41
    v_perm_b32 v54, v54, v17, s42
    v_perm_b32 v55, v55, v17, s43
    global_store_dwordx4 v28, v[52:55], s[26:27] sc1
L_att_done:
    s_endpgm
L_wts:
    s_setprio 3
    s_sub_u32 s36, s3, 8
    v_lshrrev_b32 v6, 3, v1
    v_and_b32 v7, 7, v1
    v_lshlrev_b32 v7, 4, v7
    v_lshl_add_u32 v2, v6, 13, v7
    s_movk_i32 s28, 9216
    v_lshrrev_b32 v8, 4, v1
    v_and_b32 v9, 15, v1
    v_lshlrev_b32 v9, 4, v9
    v_mad_u32_u24 v3, v8, s28, v9
    s_movk_i32 s28, 1152
    v_mad_u32_u24 v4, v6, s28, v7
    v_lshrrev_b32 v8, 5, v1
    v_and_b32 v9, 31, v1
    v_mul_u32_u24 v18, 36, v9
    v_mad_u32_u24 v18, v8, s28, v18
    v_mov_b32 v160, 0
    v_mov_b32 v64, 0
    v_mov_b32 v65, 0
    v_mov_b32 v66, 0
    v_mov_b32 v67, 0
    s_mov_b32 s50, 0x00ff00ff
    s_mov_b32 s51, 0xff00ff00
    s_mov_b32 s52, 0xff00ff00
    s_mov_b32 s53, 0xff00ff00
    s_mov_b32 s54, 0xffff0000
    s_mov_b32 s55, 0xffff0000
    s_waitcnt lgkmcnt(0)
    s_and_b32 s96, s101, 0xff
    s_bfe_u32 s97, s101, 0x80008
    s_bfe_u32 s98, s101, 0x80010
    s_lshr_b32 s101, s101, 24
    global_load_dword v16, v160, s[26:27] sc1
    global_load_dwordx4 v[20:23], v18, s[4:5]
    global_load_dwordx4 v[24:27], v18, s[4:5] offset:16
    global_load_dword v28, v18, s[4:5] offset:32
    s_and_b32 s56, s97, 3
    s_lshr_b32 s57, s97, 2
    s_mul_i32 s28, s56, 1179648
    s_lshl_b32 s29, s57, 7
    s_add_u32 s28, s28, s29
    s_add_u32 s10, s10, s28
    s_addc_u32 s11, s11, 0
    s_lshl_b32 s28, s36, 16
    s_add_u32 s32, s10, s28
    s_addc_u32 s33, s11, 0
    global_load_dwordx4 v[48:51], v2, s[32:33]
    s_add_u32 s32, s32, 262144
    s_addc_u32 s33, s33, 0
    global_load_dwordx4 v[52:55], v2, s[32:33]
    s_add_u32 s32, s32, 262144
    s_addc_u32 s33, s33, 0
    global_load_dwordx4 v[56:59], v2, s[32:33]
    s_add_u32 s32, s32, 262144
    s_addc_u32 s33, s33, 0
    global_load_dwordx4 v[60:63], v2, s[32:33]
    s_lshl_b32 s28, s36, 15
    s_add_u32 s28, s28, 1048576
    s_add_u32 s32, s10, s28
    s_addc_u32 s33, s11, 0
    s_mov_b32 exec_lo, 0xffffffff
    s_mov_b32 exec_hi, 0x0
    global_load_dwordx4 v[64:67], v2, s[32:33]
    s_mov_b64 exec, -1
    s_waitcnt lgkmcnt(0)
    s_barrier
    s_cmp_ge_u32 s98, 108
    s_cselect_b32 s28, 108, 0
    s_cselect_b32 s16, s18, s16
    s_cselect_b32 s17, s19, s17
    s_sub_u32 s29, s98, s28
    s_mul_hi_u32 s58, s29, 0x55555556
    s_mul_i32 s59, s58, 3
    s_sub_u32 s59, s29, s59
    s_mul_i32 s28, s59, 1769472
    s_min_u32 s29, s58, 35
    s_lshl_b32 s29, s29, 8
    s_add_u32 s28, s28, s29
    s_mul_i32 s29, s36, 36864
    s_add_u32 s28, s28, s29
    s_add_u32 s16, s16, s28
    s_addc_u32 s17, s17, 0
    v_lshrrev_b32 v6, 3, v1
    v_and_b32 v6, 1, v6
    v_lshrrev_b32 v7, 4, v1
    s_movk_i32 s28, 2304
    v_mul_u32_u24 v5, 0x900, v6
    v_add_u32 v5, 131072, v5
    v_and_b32 v19, 1, v7
    v_lshl_add_u32 v19, v19, 3, v5
    v_lshl_add_u32 v5, v7, 3, v5
    v_mul_u32_u24 v6, 72, v9
    v_mul_u32_u24 v7, 0x900, v8
    v_add_u32 v6, v6, v7
    v_add_u32 v6, 131072, v6
    v_lshl_add_u32 v7, v8, 2, v6
    v_xor_b32 v8, 1, v8
    v_lshl_add_u32 v8, v8, 2, v6
    s_waitcnt vmcnt(5)
    v_lshlrev_b32 v30, 16, v20
    v_and_b32 v31, 0xffff0000, v20
    v_lshlrev_b32 v32, 16, v21
    v_and_b32 v33, 0xffff0000, v21
    v_lshlrev_b32 v34, 16, v22
    v_and_b32 v35, 0xffff0000, v22
    v_lshlrev_b32 v36, 16, v23
    v_and_b32 v37, 0xffff0000, v23
    v_lshlrev_b32 v38, 16, v24
    v_and_b32 v39, 0xffff0000, v24
    v_lshlrev_b32 v40, 16, v25
    v_and_b32 v41, 0xffff0000, v25
    v_lshlrev_b32 v42, 16, v26
    v_and_b32 v43, 0xffff0000, v26
    v_lshlrev_b32 v44, 16, v27
    v_and_b32 v45, 0xffff0000, v27
    v_lshlrev_b32 v46, 16, v28
    v_and_b32 v47, 0xffff0000, v28
    v_add_f32 v160, v30, v31
    v_add_f32 v161, v32, v33
    v_add_f32 v160, v160, v34
    v_add_f32 v160, v160, v35
    v_add_f32 v161, v161, v36
    v_add_f32 v161, v161, v37
    v_add_f32 v160, v160, v38
    v_add_f32 v160, v160, v39
    v_add_f32 v161, v161, v40
    v_add_f32 v161, v161, v41
    v_add_f32 v160, v160, v42
    v_add_f32 v160, v160, v43
    v_add_f32 v161, v161, v44
    v_add_f32 v161, v161, v45
    v_add_f32 v160, v160, v46
    v_add_f32 v160, v160, v47
    v_add_f32 v160, v160, v161
    s_nop 1
    v_add_f32_dpp v160, v160, v160 quad_perm:[1,0,3,2] row_mask:0xf bank_mask:0xf
    s_nop 1
    v_add_f32_dpp v160, v160, v160 quad_perm:[2,3,0,1] row_mask:0xf bank_mask:0xf
    s_nop 1
    v_add_f32_dpp v160, v160, v160 row_half_mirror row_mask:0xf bank_mask:0xf
    s_nop 1
    v_add_f32_dpp v160, v160, v160 row_mirror row_mask:0xf bank_mask:0xf
    v_mov_b32 v161, v160
    s_nop 1
    v_permlane16_swap_b32 v160, v161
    v_add_f32 v160, v160, v161
    v_mul_f32 v160, 0x3ae38e39, v160
    v_sub_f32 v162, v30, v160
    v_mul_f32 v161, v162, v162
    v_sub_f32 v163, v31, v160
    v_mul_f32 v164, v163, v163
    v_sub_f32 v162, v32, v160
    v_sub_f32 v163, v33, v160
    v_fmac_f32 v161, v162, v162
    v_fmac_f32 v164, v163, v163
    v_sub_f32 v162, v34, v160
    v_sub_f32 v163, v35, v160
    v_fmac_f32 v161, v162, v162
    v_fmac_f32 v164, v163, v163
    v_sub_f32 v162, v36, v160
    v_sub_f32 v163, v37, v160
    v_fmac_f32 v161, v162, v162
    v_fmac_f32 v164, v163, v163
    v_sub_f32 v162, v38, v160
    v_sub_f32 v163, v39, v160
    v_fmac_f32 v161, v162, v162
    v_fmac_f32 v164, v163, v163
    v_sub_f32 v162, v40, v160
    v_sub_f32 v163, v41, v160
    v_fmac_f32 v161, v162, v162
    v_fmac_f32 v164, v163, v163
    v_sub_f32 v162, v42, v160
    v_sub_f32 v163, v43, v160
    v_fmac_f32 v161, v162, v162
    v_fmac_f32 v164, v163, v163
    v_sub_f32 v162, v44, v160
    v_sub_f32 v163, v45, v160
    v_fmac_f32 v161, v162, v162
    v_fmac_f32 v164, v163, v163
    v_sub_f32 v162, v46, v160
    v_sub_f32 v163, v47, v160
    v_fmac_f32 v161, v162, v162
    v_fmac_f32 v164, v163, v163
    v_add_f32 v161, v161, v164
    s_nop 1
    v_add_f32_dpp v161, v161, v161 quad_perm:[1,0,3,2] row_mask:0xf bank_mask:0xf
    s_nop 1
    v_add_f32_dpp v161, v161, v161 quad_perm:[2,3,0,1] row_mask:0xf bank_mask:0xf
    s_nop 1
    v_add_f32_dpp v161, v161, v161 row_half_mirror row_mask:0xf bank_mask:0xf
    s_nop 1
    v_add_f32_dpp v161, v161, v161 row_mirror row_mask:0xf bank_mask:0xf
    v_mov_b32 v162, v161
    s_nop 1
    v_permlane16_swap_b32 v161, v162
    v_add_f32 v161, v161, v162
    v_mul_f32 v161, 0x3ae38e39, v161
    v_cvt_pk_bf16_f32 v160, v160, v161
    v_and_b32 v161, 0xffff0000, v160
    v_lshlrev_b32 v160, 16, v160
    v_add_f32 v161, 0x3727c5ac, v161
    v_cvt_pk_bf16_f32 v161, v161, v161
    v_and_b32 v161, 0xffff0000, v161
    v_sqrt_f32 v161, v161
    s_nop 0
    v_cvt_pk_bf16_f32 v161, v161, v161
    v_and_b32 v161, 0xffff0000, v161
    v_rcp_f32 v162, v161
    v_sub_f32 v30, v30, v160
    v_sub_f32 v31, v31, v160
    v_cvt_pk_bf16_f32 v163, v30, v31
    v_lshlrev_b32 v30, 16, v163
    v_and_b32 v31, 0xffff0000, v163
    v_mul_f32 v164, v30, v162
    v_mul_f32 v165, v31, v162
    v_fma_f32 v30, -v164, v161, v30
    v_fma_f32 v31, -v165, v161, v31
    v_fmac_f32 v164, v30, v162
    v_fmac_f32 v165, v31, v162
    v_cvt_pk_bf16_f32 v30, v164, v164
    v_cvt_pk_bf16_f32 v31, v165, v165
    ds_write_b32 v7, v30 offset:0
    ds_write_b32 v8, v31 offset:0
    v_sub_f32 v32, v32, v160
    v_sub_f32 v33, v33, v160
    v_cvt_pk_bf16_f32 v163, v32, v33
    v_lshlrev_b32 v32, 16, v163
    v_and_b32 v33, 0xffff0000, v163
    v_mul_f32 v164, v32, v162
    v_mul_f32 v165, v33, v162
    v_fma_f32 v32, -v164, v161, v32
    v_fma_f32 v33, -v165, v161, v33
    v_fmac_f32 v164, v32, v162
    v_fmac_f32 v165, v33, v162
    v_cvt_pk_bf16_f32 v32, v164, v164
    v_cvt_pk_bf16_f32 v33, v165, v165
    ds_write_b32 v7, v32 offset:8
    ds_write_b32 v8, v33 offset:8
    v_sub_f32 v34, v34, v160
    v_sub_f32 v35, v35, v160
    v_cvt_pk_bf16_f32 v163, v34, v35
    v_lshlrev_b32 v34, 16, v163
    v_and_b32 v35, 0xffff0000, v163
    v_mul_f32 v164, v34, v162
    v_mul_f32 v165, v35, v162
    v_fma_f32 v34, -v164, v161, v34
    v_fma_f32 v35, -v165, v161, v35
    v_fmac_f32 v164, v34, v162
    v_fmac_f32 v165, v35, v162
    v_cvt_pk_bf16_f32 v34, v164, v164
    v_cvt_pk_bf16_f32 v35, v165, v165
    ds_write_b32 v7, v34 offset:16
    ds_write_b32 v8, v35 offset:16
    v_sub_f32 v36, v36, v160
    v_sub_f32 v37, v37, v160
    v_cvt_pk_bf16_f32 v163, v36, v37
    v_lshlrev_b32 v36, 16, v163
    v_and_b32 v37, 0xffff0000, v163
    v_mul_f32 v164, v36, v162
    v_mul_f32 v165, v37, v162
    v_fma_f32 v36, -v164, v161, v36
    v_fma_f32 v37, -v165, v161, v37
    v_fmac_f32 v164, v36, v162
    v_fmac_f32 v165, v37, v162
    v_cvt_pk_bf16_f32 v36, v164, v164
    v_cvt_pk_bf16_f32 v37, v165, v165
    ds_write_b32 v7, v36 offset:24
    ds_write_b32 v8, v37 offset:24
    v_sub_f32 v38, v38, v160
    v_sub_f32 v39, v39, v160
    v_cvt_pk_bf16_f32 v163, v38, v39
    v_lshlrev_b32 v38, 16, v163
    v_and_b32 v39, 0xffff0000, v163
    v_mul_f32 v164, v38, v162
    v_mul_f32 v165, v39, v162
    v_fma_f32 v38, -v164, v161, v38
    v_fma_f32 v39, -v165, v161, v39
    v_fmac_f32 v164, v38, v162
    v_fmac_f32 v165, v39, v162
    v_cvt_pk_bf16_f32 v38, v164, v164
    v_cvt_pk_bf16_f32 v39, v165, v165
    ds_write_b32 v7, v38 offset:32
    ds_write_b32 v8, v39 offset:32
    v_sub_f32 v40, v40, v160
    v_sub_f32 v41, v41, v160
    v_cvt_pk_bf16_f32 v163, v40, v41
    v_lshlrev_b32 v40, 16, v163
    v_and_b32 v41, 0xffff0000, v163
    v_mul_f32 v164, v40, v162
    v_mul_f32 v165, v41, v162
    v_fma_f32 v40, -v164, v161, v40
    v_fma_f32 v41, -v165, v161, v41
    v_fmac_f32 v164, v40, v162
    v_fmac_f32 v165, v41, v162
    v_cvt_pk_bf16_f32 v40, v164, v164
    v_cvt_pk_bf16_f32 v41, v165, v165
    ds_write_b32 v7, v40 offset:40
    ds_write_b32 v8, v41 offset:40
    v_sub_f32 v42, v42, v160
    v_sub_f32 v43, v43, v160
    v_cvt_pk_bf16_f32 v163, v42, v43
    v_lshlrev_b32 v42, 16, v163
    v_and_b32 v43, 0xffff0000, v163
    v_mul_f32 v164, v42, v162
    v_mul_f32 v165, v43, v162
    v_fma_f32 v42, -v164, v161, v42
    v_fma_f32 v43, -v165, v161, v43
    v_fmac_f32 v164, v42, v162
    v_fmac_f32 v165, v43, v162
    v_cvt_pk_bf16_f32 v42, v164, v164
    v_cvt_pk_bf16_f32 v43, v165, v165
    ds_write_b32 v7, v42 offset:48
    ds_write_b32 v8, v43 offset:48
    v_sub_f32 v44, v44, v160
    v_sub_f32 v45, v45, v160
    v_cvt_pk_bf16_f32 v163, v44, v45
    v_lshlrev_b32 v44, 16, v163
    v_and_b32 v45, 0xffff0000, v163
    v_mul_f32 v164, v44, v162
    v_mul_f32 v165, v45, v162
    v_fma_f32 v44, -v164, v161, v44
    v_fma_f32 v45, -v165, v161, v45
    v_fmac_f32 v164, v44, v162
    v_fmac_f32 v165, v45, v162
    v_cvt_pk_bf16_f32 v44, v164, v164
    v_cvt_pk_bf16_f32 v45, v165, v165
    ds_write_b32 v7, v44 offset:56
    ds_write_b32 v8, v45 offset:56
    v_sub_f32 v46, v46, v160
    v_sub_f32 v47, v47, v160
    v_cvt_pk_bf16_f32 v163, v46, v47
    v_lshlrev_b32 v46, 16, v163
    v_and_b32 v47, 0xffff0000, v163
    v_mul_f32 v164, v46, v162
    v_mul_f32 v165, v47, v162
    v_fma_f32 v46, -v164, v161, v46
    v_fma_f32 v47, -v165, v161, v47
    v_fmac_f32 v164, v46, v162
    v_fmac_f32 v165, v47, v162
    v_cvt_pk_bf16_f32 v46, v164, v164
    v_cvt_pk_bf16_f32 v47, v165, v165
    ds_write_b32 v7, v46 offset:64
    ds_write_b32 v8, v47 offset:64
    v_add_u32 v16, 1, v16
    s_mov_b32 s28, 0x9E3779B1
    v_mul_lo_u32 v17, v16, s28
    v_not_b32 v160, v17
    v_and_b32 v160, 1, v160
    v_lshlrev_b32 v160, 8, v160
    v_and_b32 v17, 0xfffffeff, v17
    v_or_b32 v17, v17, v160
    s_mul_i32 s28, s56, 576
    s_lshl_b32 s29, s36, 5
    s_add_u32 s28, s28, s29
    v_add_u32 v6, s28, v5
    ds_read_b64 v[148:149], v6 offset:0
    ds_read_b64 v[150:151], v6 offset:128
    ds_read_b64 v[152:153], v6 offset:256
    ds_read_b64 v[154:155], v6 offset:384
    s_mul_i32 s28, s56, 576
    s_lshl_b32 s29, s36, 4
    s_add_u32 s28, s28, s29
    s_add_u32 s28, s28, 512
    v_add_u32 v6, s28, v19
    ds_read_b64 v[156:157], v6
    s_waitcnt vmcnt(0)
    s_waitcnt lgkmcnt(0)
    v_and_b32 v140, v148, v12
    v_and_b32 v141, v148, v13
    v_and_b32 v142, v148, v14
    v_and_b32 v143, v148, v15
    v_and_b32 v144, v149, v12
    v_and_b32 v145, v149, v13
    v_and_b32 v146, v149, v14
    v_and_b32 v147, v149, v15
    v_mfma_f32_16x16x32_bf16 v[116:119], v[48:51], v[140:143], 0
    s_nop 0
    v_mfma_f32_16x16x32_bf16 v[120:123], v[48:51], v[144:147], 0
    v_and_b32 v140, v150, v12
    v_and_b32 v141, v150, v13
    v_and_b32 v142, v150, v14
    v_and_b32 v143, v150, v15
    v_and_b32 v144, v151, v12
    v_and_b32 v145, v151, v13
    v_and_b32 v146, v151, v14
    v_and_b32 v147, v151, v15
    v_mfma_f32_16x16x32_bf16 v[116:119], v[52:55], v[140:143], v[116:119]
    s_nop 0
    v_mfma_f32_16x16x32_bf16 v[120:123], v[52:55], v[144:147], v[120:123]
    v_and_b32 v140, v152, v12
    v_and_b32 v141, v152, v13
    v_and_b32 v142, v152, v14
    v_and_b32 v143, v152, v15
    v_and_b32 v144, v153, v12
    v_and_b32 v145, v153, v13
    v_and_b32 v146, v153, v14
    v_and_b32 v147, v153, v15
    v_mfma_f32_16x16x32_bf16 v[116:119], v[56:59], v[140:143], v[116:119]
    s_nop 0
    v_mfma_f32_16x16x32_bf16 v[120:123], v[56:59], v[144:147], v[120:123]
    v_and_b32 v140, v154, v12
    v_and_b32 v141, v154, v13
    v_and_b32 v142, v154, v14
    v_and_b32 v143, v154, v15
    v_and_b32 v144, v155, v12
    v_and_b32 v145, v155, v13
    v_and_b32 v146, v155, v14
    v_and_b32 v147, v155, v15
    v_mfma_f32_16x16x32_bf16 v[116:119], v[60:63], v[140:143], v[116:119]
    s_nop 0
    v_mfma_f32_16x16x32_bf16 v[120:123], v[60:63], v[144:147], v[120:123]
    v_and_b32 v140, v156, v12
    v_and_b32 v141, v156, v13
    v_and_b32 v142, v156, v14
    v_and_b32 v143, v156, v15
    v_and_b32 v144, v157, v12
    v_and_b32 v145, v157, v13
    v_and_b32 v146, v157, v14
    v_and_b32 v147, v157, v15
    v_mfma_f32_16x16x32_bf16 v[116:119], v[64:67], v[140:143], v[116:119]
    s_nop 0
    v_mfma_f32_16x16x32_bf16 v[120:123], v[64:67], v[144:147], v[120:123]
    s_nop 7
    v_cndmask_b32_e64 v116, v120, v116, s[50:51]
    v_cndmask_b32_e64 v117, v121, v117, s[50:51]
    v_cndmask_b32_e64 v118, v122, v118, s[50:51]
    v_cndmask_b32_e64 v119, v123, v119, s[50:51]
    v_lshlrev_b32 v18, 4, v1
    s_lshl_b32 s28, s36, 10
    s_add_u32 s28, s28, 136192
    v_add_u32 v6, s28, v18
    ds_write_b128 v6, v[116:119]
    s_mov_b64 exec, 1
    ds_add_rtn_u32 v160, v10, v11 offset:0
    s_waitcnt lgkmcnt(0)
    v_readfirstlane_b32 s49, v160
    s_mov_b64 exec, -1
    s_cmp_lg_u32 s49, 3
    s_cbranch_scc1 L_noqpub_7
    v_and_b32 v6, 31, v1
    v_lshlrev_b32 v6, 4, v6
    v_lshrrev_b32 v7, 5, v1
    v_lshl_add_u32 v6, v7, 3, v6
    v_add_u32 v6, 136192, v6
    ds_read_b64 v[30:31], v6 offset:0
    ds_read_b64 v[32:33], v6 offset:512
    ds_read_b64 v[34:35], v6 offset:1024
    ds_read_b64 v[36:37], v6 offset:1536
    ds_read_b64 v[38:39], v6 offset:2048
    ds_read_b64 v[40:41], v6 offset:2560
    ds_read_b64 v[42:43], v6 offset:3072
    ds_read_b64 v[44:45], v6 offset:3584
    v_lshrrev_b32 v8, 3, v1
    v_and_b32 v8, 1, v8
    v_lshlrev_b32 v8, 9, v8
    v_lshl_add_u32 v8, v7, 8, v8
    v_lshrrev_b32 v9, 4, v1
    v_and_b32 v9, 1, v9
    v_lshl_add_u32 v8, v9, 7, v8
    v_and_b32 v9, 7, v1
    v_lshl_add_u32 v8, v9, 4, v8
    s_lshl_b32 s28, s97, 10
    s_add_u32 s28, s28, 65536
    v_add_u32 v8, s28, v8
    s_waitcnt lgkmcnt(0)
    v_add_f32 v30, v30, v32
    v_add_f32 v31, v31, v33
    v_add_f32 v34, v34, v36
    v_add_f32 v35, v35, v37
    v_add_f32 v38, v38, v40
    v_add_f32 v39, v39, v41
    v_add_f32 v42, v42, v44
    v_add_f32 v43, v43, v45
    v_add_f32 v30, v30, v34
    v_add_f32 v31, v31, v35
    v_add_f32 v38, v38, v42
    v_add_f32 v39, v39, v43
    v_add_f32 v30, v30, v38
    v_add_f32 v32, v31, v39
    v_mov_b32 v31, v16
    v_mov_b32 v33, v16
    global_store_dwordx4 v8, v[30:33], s[26:27] sc1
L_noqpub_7:
    s_cmp_ge_u32 s98, 216
    s_cbranch_scc1 L_noffn1_8
    global_load_dwordx4 v[68:71], v3, s[16:17]
    s_add_u32 s16, s16, 147456
    s_addc_u32 s17, s17, 0
    global_load_dwordx4 v[72:75], v3, s[16:17]
    s_add_u32 s16, s16, 147456
    s_addc_u32 s17, s17, 0
    global_load_dwordx4 v[76:79], v3, s[16:17]
    s_add_u32 s16, s16, 147456
    s_addc_u32 s17, s17, 0
    global_load_dwordx4 v[80:83], v3, s[16:17]
    s_add_u32 s16, s16, 147456
    s_addc_u32 s17, s17, 0
    global_load_dwordx4 v[84:87], v3, s[16:17]
    s_add_u32 s16, s16, 147456
    s_addc_u32 s17, s17, 0
    global_load_dwordx4 v[88:91], v3, s[16:17]
    s_add_u32 s16, s16, 147456
    s_addc_u32 s17, s17, 0
    v_lshrrev_b32 v6, 3, v1
    v_and_b32 v6, 1, v6
    v_lshrrev_b32 v7, 4, v1
    v_xor_b32 v8, v7, v6
    v_and_b32 v8, 1, v8
    v_lshlrev_b32 v8, 2, v8
    v_lshrrev_b32 v7, 1, v7
    v_lshl_add_u32 v8, v7, 3, v8
    v_mul_u32_u24 v6, 0x900, v6
    v_add_u32 v6, v6, v8
    s_mul_i32 s28, s59, 768
    s_lshl_b32 s29, s36, 4
    s_add_u32 s28, s28, s29
    s_add_u32 s28, s28, 131072
    v_add_u32 v6, s28, v6
    ds_read_b32 v148, v6 offset:0
    ds_read_b32 v149, v6 offset:64
    ds_read_b32 v150, v6 offset:128
    ds_read_b32 v151, v6 offset:192
    ds_read_b32 v152, v6 offset:256
    ds_read_b32 v153, v6 offset:320
    ds_read_b32 v154, v6 offset:384
    ds_read_b32 v155, v6 offset:448
    ds_read_b32 v156, v6 offset:512
    ds_read_b32 v157, v6 offset:576
    ds_read_b32 v158, v6 offset:640
    ds_read_b32 v159, v6 offset:704
    s_waitcnt lgkmcnt(0)
    s_waitcnt vmcnt(0)
L_noffn1_8:
    s_lshr_b32 s28, s96, 3
    s_lshr_b32 s60, s28, 4
    s_and_b32 s61, s28, 15
    s_lshr_b32 s28, s96, 3
    s_lshr_b32 s60, s28, 4
    s_and_b32 s61, s28, 15
    s_lshl_b32 s28, s61, 2
    s_add_u32 s28, s28, s36
    s_lshl_b32 s28, s28, 12
    s_lshl_b32 s29, s60, 9
    s_add_u32 s28, s28, s29
    s_add_u32 s28, s28, 65536
    v_and_b32 v6, 3, v1
    v_lshlrev_b32 v6, 10, v6
    v_lshrrev_b32 v7, 2, v1
    v_and_b32 v7, 7, v7
    v_lshl_add_u32 v6, v7, 4, v6
    v_lshrrev_b32 v8, 5, v1
    v_lshl_add_u32 v6, v8, 7, v6
    v_add_u32 v6, s28, v6
    global_load_dwordx4 v[30:33], v6, s[26:27] sc1
    global_load_dwordx4 v[34:37], v6, s[26:27] offset:256 sc1
    s_cmp_ge_u32 s98, 216
    s_cbranch_scc1 L_q0_9
    global_load_dwordx4 v[92:95], v3, s[16:17]
    s_add_u32 s16, s16, 147456
    s_addc_u32 s17, s17, 0
    global_load_dwordx4 v[96:99], v3, s[16:17]
    s_add_u32 s16, s16, 147456
    s_addc_u32 s17, s17, 0
    global_load_dwordx4 v[100:103], v3, s[16:17]
    s_add_u32 s16, s16, 147456
    s_addc_u32 s17, s17, 0
    global_load_dwordx4 v[104:107], v3, s[16:17]
    s_add_u32 s16, s16, 147456
    s_addc_u32 s17, s17, 0
    global_load_dwordx4 v[108:111], v3, s[16:17]
    s_add_u32 s16, s16, 147456
    s_addc_u32 s17, s17, 0
    global_load_dwordx4 v[112:115], v3, s[16:17]
    s_waitcnt vmcnt(6)
    s_branch L_q1_10
L_q0_9:
    s_waitcnt vmcnt(0)
L_q1_10:
    v_bitop3_b32 v160, v31, v33, v16 bitop3:0x7e
    v_bitop3_b32 v161, v35, v37, v16 bitop3:0x7e
    v_or_b32 v160, v160, v161
    v_cmp_ne_u32 vcc, 0, v160
    s_cbranch_vccz L_q2_11
    s_mov_b64 exec, vcc
    s_mov_b32 s30, 0
L_poll_12:
    global_load_dwordx4 v[30:33], v6, s[26:27] sc1
    global_load_dwordx4 v[34:37], v6, s[26:27] offset:256 sc1
    s_waitcnt vmcnt(0)
    v_bitop3_b32 v160, v31, v33, v16 bitop3:0x7e
    v_bitop3_b32 v161, v35, v37, v16 bitop3:0x7e
    v_or_b32 v160, v160, v161
    v_cmp_ne_u32 vcc, 0, v160
    s_cbranch_vccz L_polld_13
    s_mov_b64 exec, vcc
    s_add_u32 s30, s30, 1
    s_cmp_lt_u32 s30, 32768
    s_cbranch_scc1 L_poll_12
L_polld_13:
    s_mov_b64 exec, -1
L_q2_11:
    s_nop 0
    v_add_f32_dpp v30, v30, v30 quad_perm:[1,0,3,2] row_mask:0xf bank_mask:0xf
    v_add_f32_dpp v32, v32, v32 quad_perm:[1,0,3,2] row_mask:0xf bank_mask:0xf
    v_add_f32_dpp v34, v34, v34 quad_perm:[1,0,3,2] row_mask:0xf bank_mask:0xf
    v_add_f32_dpp v36, v36, v36 quad_perm:[1,0,3,2] row_mask:0xf bank_mask:0xf
    v_add_f32_dpp v30, v30, v30 quad_perm:[2,3,0,1] row_mask:0xf bank_mask:0xf
    v_add_f32_dpp v32, v32, v32 quad_perm:[2,3,0,1] row_mask:0xf bank_mask:0xf
    v_add_f32_dpp v34, v34, v34 quad_perm:[2,3,0,1] row_mask:0xf bank_mask:0xf
    v_add_f32_dpp v36, v36, v36 quad_perm:[2,3,0,1] row_mask:0xf bank_mask:0xf
    v_cvt_pk_bf16_f32 v30, v30, v30
    v_cvt_pk_bf16_f32 v32, v32, v32
    v_cvt_pk_bf16_f32 v34, v34, v34
    v_cvt_pk_bf16_f32 v36, v36, v36
    s_lshr_b32 s28, s36, 1
    s_lshl_b32 s28, s28, 8
    s_and_b32 s29, s36, 1
    s_lshl_b32 s29, s29, 7
    s_add_u32 s28, s28, s29
    s_add_u32 s28, s28, 135680
    v_lshlrev_b32 v8, 6, v8
    v_lshl_add_u32 v8, v7, 1, v8
    v_add_u32 v8, s28, v8
    s_mov_b32 exec_lo, 0x11111111
    s_mov_b32 exec_hi, 0x11111111
    ds_write_b16 v8, v30 offset:0
    ds_write_b16 v8, v32 offset:16
    ds_write_b16 v8, v34 offset:32
    ds_write_b16 v8, v36 offset:48
    s_mov_b64 exec, -1
    s_mov_b64 exec, 1
    ds_add_u32 v10, v11 offset:8
    s_mov_b64 exec, -1
    s_cmp_ge_u32 s98, 216
    s_cbranch_scc1 L_noffn2_14
    v_and_b32 v140, v148, v12
    v_and_b32 v141, v148, v13
    v_and_b32 v142, v148, v14
    v_and_b32 v143, v148, v15
    s_nop 1
    v_mfma_f32_16x16x32_bf16 v[116:119], v[68:71], v[140:143], 0
    v_and_b32 v144, v149, v12
    v_and_b32 v145, v149, v13
    v_and_b32 v146, v149, v14
    v_and_b32 v147, v149, v15
    s_nop 1
    v_mfma_f32_16x16x32_bf16 v[116:119], v[72:75], v[144:147], v[116:119]
    v_and_b32 v140, v150, v12
    v_and_b32 v141, v150, v13
    v_and_b32 v142, v150, v14
    v_and_b32 v143, v150, v15
    s_nop 1
    v_mfma_f32_16x16x32_bf16 v[116:119], v[76:79], v[140:143], v[116:119]
    v_and_b32 v144, v151, v12
    v_and_b32 v145, v151, v13
    v_and_b32 v146, v151, v14
    v_and_b32 v147, v151, v15
    s_nop 1
    v_mfma_f32_16x16x32_bf16 v[116:119], v[80:83], v[144:147], v[116:119]
    v_and_b32 v140, v152, v12
    v_and_b32 v141, v152, v13
    v_and_b32 v142, v152, v14
    v_and_b32 v143, v152, v15
    s_nop 1
    v_mfma_f32_16x16x32_bf16 v[116:119], v[84:87], v[140:143], v[116:119]
    v_and_b32 v144, v153, v12
    v_and_b32 v145, v153, v13
    v_and_b32 v146, v153, v14
    v_and_b32 v147, v153, v15
    s_nop 1
    v_mfma_f32_16x16x32_bf16 v[116:119], v[88:91], v[144:147], v[116:119]
    v_and_b32 v140, v154, v12
    v_and_b32 v141, v154, v13
    v_and_b32 v142, v154, v14
    v_and_b32 v143, v154, v15
    s_waitcnt vmcnt(5)
    s_nop 0
    v_mfma_f32_16x16x32_bf16 v[116:119], v[92:95], v[140:143], v[116:119]
    v_and_b32 v144, v155, v12
    v_and_b32 v145, v155, v13
    v_and_b32 v146, v155, v14
    v_and_b32 v147, v155, v15
    s_waitcnt vmcnt(4)
    s_nop 0
    v_mfma_f32_16x16x32_bf16 v[116:119], v[96:99], v[144:147], v[116:119]
    v_and_b32 v140, v156, v12
    v_and_b32 v141, v156, v13
    v_and_b32 v142, v156, v14
    v_and_b32 v143, v156, v15
    s_waitcnt vmcnt(3)
    s_nop 0
    v_mfma_f32_16x16x32_bf16 v[116:119], v[100:103], v[140:143], v[116:119]
    v_and_b32 v144, v157, v12
    v_and_b32 v145, v157, v13
    v_and_b32 v146, v157, v14
    v_and_b32 v147, v157, v15
    s_waitcnt vmcnt(2)
    s_nop 0
    v_mfma_f32_16x16x32_bf16 v[116:119], v[104:107], v[144:147], v[116:119]
    v_and_b32 v140, v158, v12
    v_and_b32 v141, v158, v13
    v_and_b32 v142, v158, v14
    v_and_b32 v143, v158, v15
    s_waitcnt vmcnt(1)
    s_nop 0
    v_mfma_f32_16x16x32_bf16 v[116:119], v[108:111], v[140:143], v[116:119]
    v_and_b32 v144, v159, v12
    v_and_b32 v145, v159, v13
    v_and_b32 v146, v159, v14
    v_and_b32 v147, v159, v15
    s_waitcnt vmcnt(0)
    s_nop 0
    v_mfma_f32_16x16x32_bf16 v[116:119], v[112:115], v[144:147], v[116:119]
    s_lshl_b32 s28, s36, 10
    s_add_u32 s28, s28, 140288
    v_add_u32 v6, s28, v18
    s_nop 4
    ds_write_b128 v6, v[116:119]
    s_mov_b64 exec, 1
    ds_add_rtn_u32 v160, v10, v11 offset:4
    s_waitcnt lgkmcnt(0)
    v_readfirstlane_b32 s49, v160
    s_mov_b64 exec, -1
    s_cmp_lg_u32 s49, 3
    s_cbranch_scc1 L_noffn2_14
    v_add_u32 v6, 140288, v18
    ds_read_b128 v[68:71], v6 offset:0
    ds_read_b128 v[72:75], v6 offset:1024
    ds_read_b128 v[76:79], v6 offset:2048
    ds_read_b128 v[80:83], v6 offset:3072
    s_lshl_b32 s28, s98, 10
    s_add_u32 s28, s28, 393216
    v_add_u32 v8, s28, v18
    s_waitcnt lgkmcnt(0)
    v_add_f32 v68, v68, v72
    v_add_f32 v69, v69, v73
    v_add_f32 v70, v70, v74
    v_add_f32 v71, v71, v75
    v_add_f32 v76, v76, v80
    v_add_f32 v77, v77, v81
    v_add_f32 v78, v78, v82
    v_add_f32 v79, v79, v83
    v_add_f32 v68, v68, v76
    v_add_f32 v69, v69, v77
    v_add_f32 v70, v70, v78
    v_add_f32 v71, v71, v79
    v_perm_b32 v68, v68, v17, s40
    v_perm_b32 v69, v69, v17, s41
    v_perm_b32 v70, v70, v17, s42
    v_perm_b32 v71, v71, v17, s43
    global_store_dwordx4 v8, v[68:71], s[26:27] sc1
L_noffn2_14:
    s_cmp_lt_u32 s101, 144
    s_cbranch_scc1 L_wtype
    s_cmp_lt_u32 s101, 160
    s_cbranch_scc1 L_wts_done
    s_sub_u32 s28, s101, 160
    s_mul_hi_u32 s62, s28, 0x55555556
    s_mul_i32 s29, s62, 3
    s_sub_u32 s63, s28, s29
    v_and_b32 v5, 7, v1
    v_lshlrev_b32 v5, 4, v5
    s_lshl_b32 s28, s62, 8
    s_add_u32 s28, s28, 655360
    v_add_u32 v5, s28, v5
    s_mul_i32 s28, s62, 147456
    s_mul_i32 s29, s63, 384
    s_add_u32 s28, s28, s29
    s_mul_i32 s29, s36, 36864
    s_add_u32 s28, s28, s29
    s_add_u32 s12, s12, s28
    s_addc_u32 s13, s13, 0
    s_lshr_b32 s28, s62, 1
    s_lshl_b32 s28, s28, 13
    s_and_b32 s29, s62, 1
    s_lshl_b32 s29, s29, 9
    s_add_u32 s28, s28, s29
    s_lshl_b32 s29, s36, 7
    s_add_u32 s28, s28, s29
    s_add_u32 s28, s28, 720896
    v_and_b32 v6, 7, v1
    v_lshlrev_b32 v6, 10, v6
    v_lshrrev_b32 v7, 3, v1
    v_lshl_add_u32 v6, v7, 4, v6
    v_add_u32 v6, s28, v6
    v_add_u32 v7, 131072, v6
    v_lshrrev_b32 v9, 3, v1
    v_and_b32 v9, 3, v9
    s_movk_i32 s28, 10240
    v_mul_u32_u24 v9, s28, v9
    v_and_b32 v8, 7, v1
    v_lshl_add_u32 v9, v8, 4, v9
    s_mul_i32 s28, s63, 12
    s_lshl_b32 s29, s36, 2
    s_add_u32 s28, s28, s29
    s_mul_i32 s28, s28, 10240
    s_lshl_b32 s29, s62, 7
    s_add_u32 s28, s28, s29
    s_add_u32 s28, s28, 1048576
    v_add_u32 v9, s28, v9
    s_mul_i32 s28, s36, 3072
    s_add_u32 s28, s28, 148480
    v_add_u32 v8, s28, v18
    s_lshl_b32 s28, s36, 10
    s_add_u32 s28, s28, 148480
    v_add_u32 v19, s28, v18
    s_mov_b32 s48, 0x3fb8aa3b
    s_lshr_b32 s57, s62, 1
    s_mov_b32 s30, 0
L_spin_15:
    ds_read_b32 v160, v10 offset:20
    s_waitcnt lgkmcnt(0)
    v_readfirstlane_b32 s29, v160
    s_nop 0
    s_cmp_ge_u32 s29, 8
    s_cbranch_scc1 L_spind_16
    s_add_u32 s30, s30, 1
    s_cmp_lt_u32 s30, 1048576
    s_cbranch_scc1 L_spin_15
L_spind_16:
    s_setprio 3
    global_load_dwordx4 v[68:71], v4, s[12:13] offset:0
    global_load_dwordx4 v[72:75], v4, s[12:13] offset:128
    global_load_dwordx4 v[76:79], v4, s[12:13] offset:256
    s_add_u32 s12, s12, 9216
    s_addc_u32 s13, s13, 0
    global_load_dwordx4 v[80:83], v4, s[12:13] offset:0
    global_load_dwordx4 v[84:87], v4, s[12:13] offset:128
    global_load_dwordx4 v[88:91], v4, s[12:13] offset:256
    s_add_u32 s12, s12, 9216
    s_addc_u32 s13, s13, 0
    global_load_dwordx4 v[92:95], v4, s[12:13] offset:0
    global_load_dwordx4 v[96:99], v4, s[12:13] offset:128
    global_load_dwordx4 v[100:103], v4, s[12:13] offset:256
    s_add_u32 s12, s12, 9216
    s_addc_u32 s13, s13, 0
    global_load_dwordx4 v[104:107], v4, s[12:13] offset:0
    global_load_dwordx4 v[108:111], v4, s[12:13] offset:128
    global_load_dwordx4 v[112:115], v4, s[12:13] offset:256
    s_mov_b32 s30, 0
    s_mov_b32 s31, 0
    s_mov_b64 s[32:33], -1
    s_mov_b64 s[34:35], -1
L_opoll_17:
    s_mov_b64 exec, s[32:33]
    s_cbranch_execz L_oskip_21
    s_cmp_lg_u32 s31, 0
    s_cbranch_scc1 L_oskipm_22
    global_load_dwordx4 v[20:23], v5, s[26:27] offset:0 sc1
L_oskipm_22:
    global_load_dwordx4 v[30:33], v6, s[26:27] sc1
L_oskip_21:
    s_mov_b64 exec, s[34:35]
    s_cbranch_execz L_oskip_23
    s_cmp_lg_u32 s31, 0
    s_cbranch_scc1 L_oskipm_24
    global_load_dwordx4 v[24:27], v5, s[26:27] offset:128 sc1
L_oskipm_24:
    global_load_dwordx4 v[34:37], v7, s[26:27] sc1
L_oskip_23:
    s_mov_b64 exec, -1
    s_waitcnt vmcnt(0)
    s_mov_b64 s[38:39], 0
    s_mov_b64 s[56:57], 0
    s_cmp_lg_u32 s31, 0
    s_cbranch_scc1 L_opollf_18
    v_perm_b32 v161, v21, v20, s44
    v_perm_b32 v162, v23, v22, s45
    v_bitop3_b32 v160, v161, v162, v17 bitop3:0x56
    v_perm_b32 v161, v25, v24, s44
    v_perm_b32 v162, v27, v26, s45
    v_bitop3_b32 v163, v161, v162, v17 bitop3:0x56
    v_cmp_ne_u32 s[38:39], 0, v160
    v_cmp_ne_u32 s[56:57], 0, v163
    s_nop 0
    s_or_b64 s[58:59], s[38:39], s[56:57]
    s_cbranch_scc1 L_opollf_18
    v_and_b32 v20, s46, v20
    v_and_b32 v21, s46, v21
    v_mov_b32 v23, v22
    v_mov_b32 v22, v20
    v_and_b32 v24, s46, v24
    v_and_b32 v25, s46, v25
    v_mov_b32 v27, v26
    v_mov_b32 v26, v24
    v_max_f32_dpp v22, v22, v22 quad_perm:[1,0,3,2] row_mask:0xf bank_mask:0xf
    s_nop 0
    v_max_f32_dpp v26, v26, v26 quad_perm:[1,0,3,2] row_mask:0xf bank_mask:0xf
    v_max_f32_dpp v22, v22, v22 quad_perm:[2,3,0,1] row_mask:0xf bank_mask:0xf
    s_nop 0
    v_max_f32_dpp v26, v26, v26 quad_perm:[2,3,0,1] row_mask:0xf bank_mask:0xf
    v_max_f32_dpp v22, v22, v22 row_half_mirror row_mask:0xf bank_mask:0xf
    s_nop 0
    v_max_f32_dpp v26, v26, v26 row_half_mirror row_mask:0xf bank_mask:0xf
    v_sub_f32 v20, v20, v22
    v_mul_f32 v20, s48, v20
    v_exp_f32 v20, v20
    v_sub_f32 v24, v24, v26
    v_mul_f32 v24, s48, v24
    v_exp_f32 v24, v24
    v_mul_f32 v21, v21, v20
    v_mul_f32 v25, v25, v24
    s_nop 0
    v_add_f32_dpp v21, v21, v21 quad_perm:[1,0,3,2] row_mask:0xf bank_mask:0xf
    v_add_f32_dpp v25, v25, v25 quad_perm:[1,0,3,2] row_mask:0xf bank_mask:0xf
    s_nop 0
    v_add_f32_dpp v21, v21, v21 quad_perm:[2,3,0,1] row_mask:0xf bank_mask:0xf
    v_add_f32_dpp v25, v25, v25 quad_perm:[2,3,0,1] row_mask:0xf bank_mask:0xf
    s_nop 0
    v_add_f32_dpp v21, v21, v21 row_half_mirror row_mask:0xf bank_mask:0xf
    v_add_f32_dpp v25, v25, v25 row_half_mirror row_mask:0xf bank_mask:0xf
    v_rcp_f32 v22, v21
    v_rcp_f32 v26, v25
    v_mul_f32 v28, v20, v22
    v_mul_f32 v29, v24, v26
    s_mov_b32 s31, 1
L_opollf_18:
    v_perm_b32 v161, v31, v30, s44
    v_perm_b32 v162, v33, v32, s45
    v_bitop3_b32 v160, v161, v162, v17 bitop3:0x56
    v_perm_b32 v161, v35, v34, s44
    v_perm_b32 v162, v37, v36, s45
    v_bitop3_b32 v163, v161, v162, v17 bitop3:0x56
    v_cmp_ne_u32 s[32:33], 0, v160
    v_cmp_ne_u32 s[34:35], 0, v163
    s_or_b64 s[32:33], s[32:33], s[38:39]
    s_or_b64 s[34:35], s[34:35], s[56:57]
    s_or_b64 s[58:59], s[32:33], s[34:35]
    s_cbranch_scc0 L_opolld_19
    s_add_u32 s30, s30, 1
    s_cmp_lt_u32 s30, 32768
    s_cbranch_scc1 L_opoll_17
L_opolld_19:
    v_and_b32 v30, s46, v30
    v_and_b32 v31, s46, v31
    v_and_b32 v32, s46, v32
    v_and_b32 v33, s46, v33
    v_and_b32 v34, s46, v34
    v_and_b32 v35, s46, v35
    v_and_b32 v36, s46, v36
    v_and_b32 v37, s46, v37
    v_pk_mul_f32 v[30:31], v[30:31], v[28:29] op_sel_hi:[1,0]
    v_pk_mul_f32 v[32:33], v[32:33], v[28:29] op_sel_hi:[1,0]
    v_pk_mul_f32 v[34:35], v[34:35], v[28:29] op_sel:[0,1] op_sel_hi:[1,1]
    v_pk_mul_f32 v[36:37], v[36:37], v[28:29] op_sel:[0,1] op_sel_hi:[1,1]
    v_add_f32_dpp v30, v30, v30 quad_perm:[1,0,3,2] row_mask:0xf bank_mask:0xf
    v_add_f32_dpp v31, v31, v31 quad_perm:[1,0,3,2] row_mask:0xf bank_mask:0xf
    v_add_f32_dpp v32, v32, v32 quad_perm:[1,0,3,2] row_mask:0xf bank_mask:0xf
    v_add_f32_dpp v33, v33, v33 quad_perm:[1,0,3,2] row_mask:0xf bank_mask:0xf
    v_add_f32_dpp v34, v34, v34 quad_perm:[1,0,3,2] row_mask:0xf bank_mask:0xf
    v_add_f32_dpp v35, v35, v35 quad_perm:[1,0,3,2] row_mask:0xf bank_mask:0xf
    v_add_f32_dpp v36, v36, v36 quad_perm:[1,0,3,2] row_mask:0xf bank_mask:0xf
    v_add_f32_dpp v37, v37, v37 quad_perm:[1,0,3,2] row_mask:0xf bank_mask:0xf
    v_add_f32_dpp v30, v30, v30 quad_perm:[2,3,0,1] row_mask:0xf bank_mask:0xf
    v_add_f32_dpp v31, v31, v31 quad_perm:[2,3,0,1] row_mask:0xf bank_mask:0xf
    v_add_f32_dpp v32, v32, v32 quad_perm:[2,3,0,1] row_mask:0xf bank_mask:0xf
    v_add_f32_dpp v33, v33, v33 quad_perm:[2,3,0,1] row_mask:0xf bank_mask:0xf
    v_add_f32_dpp v34, v34, v34 quad_perm:[2,3,0,1] row_mask:0xf bank_mask:0xf
    v_add_f32_dpp v35, v35, v35 quad_perm:[2,3,0,1] row_mask:0xf bank_mask:0xf
    v_add_f32_dpp v36, v36, v36 quad_perm:[2,3,0,1] row_mask:0xf bank_mask:0xf
    v_add_f32_dpp v37, v37, v37 quad_perm:[2,3,0,1] row_mask:0xf bank_mask:0xf
    v_add_f32_dpp v30, v30, v30 row_half_mirror row_mask:0xf bank_mask:0xf
    v_add_f32_dpp v31, v31, v31 row_half_mirror row_mask:0xf bank_mask:0xf
    v_add_f32_dpp v32, v32, v32 row_half_mirror row_mask:0xf bank_mask:0xf
    v_add_f32_dpp v33, v33, v33 row_half_mirror row_mask:0xf bank_mask:0xf
    v_add_f32_dpp v34, v34, v34 row_half_mirror row_mask:0xf bank_mask:0xf
    v_add_f32_dpp v35, v35, v35 row_half_mirror row_mask:0xf bank_mask:0xf
    v_add_f32_dpp v36, v36, v36 row_half_mirror row_mask:0xf bank_mask:0xf
    v_add_f32_dpp v37, v37, v37 row_half_mirror row_mask:0xf bank_mask:0xf
    v_cvt_pk_bf16_f32 v30, v30, v30
    v_cvt_pk_bf16_f32 v31, v31, v31
    v_cvt_pk_bf16_f32 v32, v32, v32
    v_cvt_pk_bf16_f32 v33, v33, v33
    v_cvt_pk_bf16_f32 v34, v34, v34
    v_cvt_pk_bf16_f32 v35, v35, v35
    v_cvt_pk_bf16_f32 v36, v36, v36
    v_cvt_pk_bf16_f32 v37, v37, v37
    v_cndmask_b32_e64 v148, v30, v34, s[52:53]
    v_cndmask_b32_e64 v150, v34, v30, s[52:53]
    v_and_b32 v140, v148, v12
    v_and_b32 v141, v148, v13
    v_mov_b32_dpp v149, v150 row_ror:8 row_mask:0xf bank_mask:0xf
    v_and_b32 v142, v148, v14
    v_and_b32 v143, v148, v15
    v_and_b32 v144, v149, v12
    v_and_b32 v145, v149, v13
    v_and_b32 v146, v149, v14
    v_and_b32 v147, v149, v15
    v_mfma_f32_16x16x32_bf16 v[116:119], v[68:71], v[140:143], 0
    v_cndmask_b32_e64 v148, v31, v35, s[52:53]
    v_cndmask_b32_e64 v150, v35, v31, s[52:53]
    v_mfma_f32_16x16x32_bf16 v[120:123], v[68:71], v[144:147], 0
    v_and_b32 v152, v148, v12
    v_and_b32 v153, v148, v13
    v_mfma_f32_16x16x32_bf16 v[124:127], v[72:75], v[140:143], 0
    v_mov_b32_dpp v149, v150 row_ror:8 row_mask:0xf bank_mask:0xf
    v_and_b32 v154, v148, v14
    v_mfma_f32_16x16x32_bf16 v[128:131], v[72:75], v[144:147], 0
    v_and_b32 v155, v148, v15
    v_and_b32 v156, v149, v12
    v_mfma_f32_16x16x32_bf16 v[132:135], v[76:79], v[140:143], 0
    v_and_b32 v157, v149, v13
    v_and_b32 v158, v149, v14
    v_mfma_f32_16x16x32_bf16 v[136:139], v[76:79], v[144:147], 0
    v_and_b32 v159, v149, v15
    v_mfma_f32_16x16x32_bf16 v[116:119], v[80:83], v[152:155], v[116:119]
    v_cndmask_b32_e64 v148, v32, v36, s[52:53]
    v_cndmask_b32_e64 v150, v36, v32, s[52:53]
    v_mfma_f32_16x16x32_bf16 v[120:123], v[80:83], v[156:159], v[120:123]
    v_and_b32 v140, v148, v12
    v_and_b32 v141, v148, v13
    v_mfma_f32_16x16x32_bf16 v[124:127], v[84:87], v[152:155], v[124:127]
    v_mov_b32_dpp v149, v150 row_ror:8 row_mask:0xf bank_mask:0xf
    v_and_b32 v142, v148, v14
    v_mfma_f32_16x16x32_bf16 v[128:131], v[84:87], v[156:159], v[128:131]
    v_and_b32 v143, v148, v15
    v_and_b32 v144, v149, v12
    v_mfma_f32_16x16x32_bf16 v[132:135], v[88:91], v[152:155], v[132:135]
    v_and_b32 v145, v149, v13
    v_and_b32 v146, v149, v14
    v_mfma_f32_16x16x32_bf16 v[136:139], v[88:91], v[156:159], v[136:139]
    v_and_b32 v147, v149, v15
    v_mfma_f32_16x16x32_bf16 v[116:119], v[92:95], v[140:143], v[116:119]
    v_cndmask_b32_e64 v148, v33, v37, s[52:53]
    v_cndmask_b32_e64 v150, v37, v33, s[52:53]
    v_mfma_f32_16x16x32_bf16 v[120:123], v[92:95], v[144:147], v[120:123]
    v_and_b32 v152, v148, v12
    v_and_b32 v153, v148, v13
    v_mfma_f32_16x16x32_bf16 v[124:127], v[96:99], v[140:143], v[124:127]
    v_mov_b32_dpp v149, v150 row_ror:8 row_mask:0xf bank_mask:0xf
    v_and_b32 v154, v148, v14
    v_mfma_f32_16x16x32_bf16 v[128:131], v[96:99], v[144:147], v[128:131]
    v_and_b32 v155, v148, v15
    v_and_b32 v156, v149, v12
    v_mfma_f32_16x16x32_bf16 v[132:135], v[100:103], v[140:143], v[132:135]
    v_and_b32 v157, v149, v13
    v_and_b32 v158, v149, v14
    v_mfma_f32_16x16x32_bf16 v[136:139], v[100:103], v[144:147], v[136:139]
    v_and_b32 v159, v149, v15
    v_mfma_f32_16x16x32_bf16 v[116:119], v[104:107], v[152:155], v[116:119]
    s_nop 0
    v_mfma_f32_16x16x32_bf16 v[120:123], v[104:107], v[156:159], v[120:123]
    v_mfma_f32_16x16x32_bf16 v[124:127], v[108:111], v[152:155], v[124:127]
    v_mfma_f32_16x16x32_bf16 v[128:131], v[108:111], v[156:159], v[128:131]
    v_mfma_f32_16x16x32_bf16 v[132:135], v[112:115], v[152:155], v[132:135]
    v_mfma_f32_16x16x32_bf16 v[136:139], v[112:115], v[156:159], v[136:139]
    s_nop 3
    v_cndmask_b32_e64 v116, v120, v116, s[50:51]
    v_cndmask_b32_e64 v117, v121, v117, s[50:51]
    v_cndmask_b32_e64 v118, v122, v118, s[50:51]
    v_cndmask_b32_e64 v119, v123, v119, s[50:51]
    ds_write_b128 v8, v[116:119] offset:0
    v_cndmask_b32_e64 v124, v128, v124, s[50:51]
    v_cndmask_b32_e64 v125, v129, v125, s[50:51]
    v_cndmask_b32_e64 v126, v130, v126, s[50:51]
    v_cndmask_b32_e64 v127, v131, v127, s[50:51]
    ds_write_b128 v8, v[124:127] offset:1024
    v_cndmask_b32_e64 v132, v136, v132, s[50:51]
    v_cndmask_b32_e64 v133, v137, v133, s[50:51]
    v_cndmask_b32_e64 v134, v138, v134, s[50:51]
    v_cndmask_b32_e64 v135, v139, v135, s[50:51]
    ds_write_b128 v8, v[132:135] offset:2048
    s_mov_b64 exec, 1
    ds_add_u32 v10, v11 offset:28
    s_mov_b64 exec, -1
    s_cmp_eq_u32 s36, 3
    s_cbranch_scc1 L_wts_done
    s_mov_b32 s30, 0
L_spin_25:
    ds_read_b32 v160, v10 offset:28
    s_waitcnt lgkmcnt(0)
    v_readfirstlane_b32 s29, v160
    s_nop 0
    s_cmp_ge_u32 s29, 4
    s_cbranch_scc1 L_spind_26
    s_add_u32 s30, s30, 1
    s_cmp_lt_u32 s30, 1048576
    s_cbranch_scc1 L_spin_25
L_spind_26:
    ds_read_b128 v[68:71], v19 offset:0
    ds_read_b128 v[72:75], v19 offset:3072
    ds_read_b128 v[76:79], v19 offset:6144
    ds_read_b128 v[80:83], v19 offset:9216
    s_waitcnt lgkmcnt(2)
    v_pk_add_f32 v[68:69], v[68:69], v[72:73]
    v_pk_add_f32 v[70:71], v[70:71], v[74:75]
    s_waitcnt lgkmcnt(0)
    v_pk_add_f32 v[76:77], v[76:77], v[80:81]
    v_pk_add_f32 v[78:79], v[78:79], v[82:83]
    v_pk_add_f32 v[68:69], v[68:69], v[76:77]
    v_pk_add_f32 v[70:71], v[70:71], v[78:79]
    v_mov_b32 v72, v68
    v_mov_b32 v73, v69
    v_mov_b32 v74, v70
    v_mov_b32 v75, v71
    v_permlane32_swap_b32 v68, v72
    v_permlane32_swap_b32 v69, v73
    v_permlane32_swap_b32 v70, v74
    v_permlane32_swap_b32 v71, v75
    v_pk_add_f32 v[68:69], v[68:69], v[72:73]
    v_pk_add_f32 v[70:71], v[70:71], v[74:75]
    v_perm_b32 v68, v68, v17, s40
    v_perm_b32 v69, v69, v17, s41
    v_perm_b32 v70, v70, v17, s42
    v_perm_b32 v71, v71, v17, s43
    s_mov_b32 exec_lo, 0xffffffff
    s_mov_b32 exec_hi, 0x0
    global_store_dwordx4 v9, v[68:71], s[26:27] sc1
    s_mov_b64 exec, -1
    s_branch L_wts_done
L_wtype:
    s_cmp_eq_u32 s36, 3
    s_cbranch_scc1 L_final
    s_mul_hi_u32 s58, s101, 0x55555556
    s_mul_i32 s59, s58, 3
    s_sub_u32 s59, s101, s59
    s_mul_i32 s28, s58, 3
    s_add_u32 s28, s28, s36
    s_lshr_b32 s29, s28, 2
    s_and_b32 s28, s28, 3
    s_mul_i32 s29, s29, 3072
    s_lshl_b32 s28, s28, 8
    s_add_u32 s28, s28, s29
    s_add_u32 s28, s28, 393216
    v_and_b32 v6, 3, v1
    v_cmp_ne_u32 s[56:57], 3, v6
    s_nop 1
    v_cndmask_b32_e64 v6, 0, v6, s[56:57]
    v_lshlrev_b32 v6, 10, v6
    v_lshrrev_b32 v7, 2, v1
    v_and_b32 v7, 1, v7
    v_mul_u32_u24 v7, 0x1b000, v7
    v_add_u32 v6, v6, v7
    v_lshrrev_b32 v7, 3, v1
    v_lshl_add_u32 v6, v7, 4, v6
    v_add_u32 v6, s28, v6
    s_mov_b32 s30, 0
L_poll_27:
    global_load_dwordx4 v[30:33], v6, s[26:27] sc1
    global_load_dwordx4 v[34:37], v6, s[26:27] offset:128 sc1
    s_waitcnt vmcnt(0)
    v_perm_b32 v161, v31, v30, s44
    v_perm_b32 v162, v33, v32, s45
    v_bitop3_b32 v160, v161, v162, v17 bitop3:0x56
    v_perm_b32 v161, v35, v34, s44
    v_perm_b32 v162, v37, v36, s45
    v_bitop3_b32 v161, v161, v162, v17 bitop3:0x56
    v_or_b32 v160, v160, v161
    v_cmp_ne_u32 vcc, 0, v160
    s_cbranch_vccz L_polld_28
    s_mov_b64 exec, vcc
    s_add_u32 s30, s30, 1
    s_cmp_lt_u32 s30, 32768
    s_cbranch_scc1 L_poll_27
L_polld_28:
    s_mov_b64 exec, -1
    v_and_b32 v30, s46, v30
    v_and_b32 v31, s46, v31
    v_and_b32 v32, s46, v32
    v_and_b32 v33, s46, v33
    v_and_b32 v34, s46, v34
    v_and_b32 v35, s46, v35
    v_and_b32 v36, s46, v36
    v_and_b32 v37, s46, v37
    v_cndmask_b32_e64 v30, 0, v30, s[56:57]
    v_cndmask_b32_e64 v31, 0, v31, s[56:57]
    v_cndmask_b32_e64 v32, 0, v32, s[56:57]
    v_cndmask_b32_e64 v33, 0, v33, s[56:57]
    v_cndmask_b32_e64 v34, 0, v34, s[56:57]
    v_cndmask_b32_e64 v35, 0, v35, s[56:57]
    v_cndmask_b32_e64 v36, 0, v36, s[56:57]
    v_cndmask_b32_e64 v37, 0, v37, s[56:57]
    v_add_f32_dpp v30, v30, v30 quad_perm:[1,0,3,2] row_mask:0xf bank_mask:0xf
    v_add_f32_dpp v31, v31, v31 quad_perm:[1,0,3,2] row_mask:0xf bank_mask:0xf
    v_add_f32_dpp v32, v32, v32 quad_perm:[1,0,3,2] row_mask:0xf bank_mask:0xf
    v_add_f32_dpp v33, v33, v33 quad_perm:[1,0,3,2] row_mask:0xf bank_mask:0xf
    v_add_f32_dpp v34, v34, v34 quad_perm:[1,0,3,2] row_mask:0xf bank_mask:0xf
    v_add_f32_dpp v35, v35, v35 quad_perm:[1,0,3,2] row_mask:0xf bank_mask:0xf
    v_add_f32_dpp v36, v36, v36 quad_perm:[1,0,3,2] row_mask:0xf bank_mask:0xf
    v_add_f32_dpp v37, v37, v37 quad_perm:[1,0,3,2] row_mask:0xf bank_mask:0xf
    v_add_f32_dpp v30, v30, v30 quad_perm:[2,3,0,1] row_mask:0xf bank_mask:0xf
    v_add_f32_dpp v31, v31, v31 quad_perm:[2,3,0,1] row_mask:0xf bank_mask:0xf
    v_add_f32_dpp v32, v32, v32 quad_perm:[2,3,0,1] row_mask:0xf bank_mask:0xf
    v_add_f32_dpp v33, v33, v33 quad_perm:[2,3,0,1] row_mask:0xf bank_mask:0xf
    v_add_f32_dpp v34, v34, v34 quad_perm:[2,3,0,1] row_mask:0xf bank_mask:0xf
    v_add_f32_dpp v35, v35, v35 quad_perm:[2,3,0,1] row_mask:0xf bank_mask:0xf
    v_add_f32_dpp v36, v36, v36 quad_perm:[2,3,0,1] row_mask:0xf bank_mask:0xf
    v_add_f32_dpp v37, v37, v37 quad_perm:[2,3,0,1] row_mask:0xf bank_mask:0xf
    v_mov_b32_dpp v38, v30 row_half_mirror row_mask:0xf bank_mask:0xf
    v_mov_b32_dpp v39, v31 row_half_mirror row_mask:0xf bank_mask:0xf
    v_mov_b32_dpp v40, v32 row_half_mirror row_mask:0xf bank_mask:0xf
    v_mov_b32_dpp v41, v33 row_half_mirror row_mask:0xf bank_mask:0xf
    v_mov_b32_dpp v42, v34 row_half_mirror row_mask:0xf bank_mask:0xf
    v_mov_b32_dpp v43, v35 row_half_mirror row_mask:0xf bank_mask:0xf
    v_mov_b32_dpp v44, v36 row_half_mirror row_mask:0xf bank_mask:0xf
    v_mov_b32_dpp v45, v37 row_half_mirror row_mask:0xf bank_mask:0xf
    s_mov_b32 s56, 0xf0f0f0f0
    s_mov_b32 s57, 0xf0f0f0f0
    s_mov_b32 s48, 0x3fb8aa3b
    v_cndmask_b32_e64 v160, v30, v38, s[56:57]
    v_cndmask_b32_e64 v161, v38, v30, s[56:57]
    v_cvt_pk_bf16_f32 v160, v160, v161
    v_and_b32 v161, 0xffff0000, v160
    v_lshlrev_b32 v160, 16, v160
    v_mul_f32 v162, s48, v160
    v_exp_f32 v162, -v162
    s_nop 0
    v_add_f32 v162, 1.0, v162
    v_rcp_f32 v163, v162
    s_nop 0
    v_mul_f32 v164, v160, v163
    v_fma_f32 v165, -v164, v162, v160
    v_fmac_f32 v164, v165, v163
    v_cvt_pk_bf16_f32 v164, v164, v164
    v_and_b32 v164, 0xffff0000, v164
    v_mul_f32 v164, v164, v161
    v_cvt_pk_bf16_f32 v30, v164, v164
    v_cndmask_b32_e64 v160, v31, v39, s[56:57]
    v_cndmask_b32_e64 v161, v39, v31, s[56:57]
    v_cvt_pk_bf16_f32 v160, v160, v161
    v_and_b32 v161, 0xffff0000, v160
    v_lshlrev_b32 v160, 16, v160
    v_mul_f32 v162, s48, v160
    v_exp_f32 v162, -v162
    s_nop 0
    v_add_f32 v162, 1.0, v162
    v_rcp_f32 v163, v162
    s_nop 0
    v_mul_f32 v164, v160, v163
    v_fma_f32 v165, -v164, v162, v160
    v_fmac_f32 v164, v165, v163
    v_cvt_pk_bf16_f32 v164, v164, v164
    v_and_b32 v164, 0xffff0000, v164
    v_mul_f32 v164, v164, v161
    v_cvt_pk_bf16_f32 v31, v164, v164
    v_cndmask_b32_e64 v160, v32, v40, s[56:57]
    v_cndmask_b32_e64 v161, v40, v32, s[56:57]
    v_cvt_pk_bf16_f32 v160, v160, v161
    v_and_b32 v161, 0xffff0000, v160
    v_lshlrev_b32 v160, 16, v160
    v_mul_f32 v162, s48, v160
    v_exp_f32 v162, -v162
    s_nop 0
    v_add_f32 v162, 1.0, v162
    v_rcp_f32 v163, v162
    s_nop 0
    v_mul_f32 v164, v160, v163
    v_fma_f32 v165, -v164, v162, v160
    v_fmac_f32 v164, v165, v163
    v_cvt_pk_bf16_f32 v164, v164, v164
    v_and_b32 v164, 0xffff0000, v164
    v_mul_f32 v164, v164, v161
    v_cvt_pk_bf16_f32 v32, v164, v164
    v_cndmask_b32_e64 v160, v33, v41, s[56:57]
    v_cndmask_b32_e64 v161, v41, v33, s[56:57]
    v_cvt_pk_bf16_f32 v160, v160, v161
    v_and_b32 v161, 0xffff0000, v160
    v_lshlrev_b32 v160, 16, v160
    v_mul_f32 v162, s48, v160
    v_exp_f32 v162, -v162
    s_nop 0
    v_add_f32 v162, 1.0, v162
    v_rcp_f32 v163, v162
    s_nop 0
    v_mul_f32 v164, v160, v163
    v_fma_f32 v165, -v164, v162, v160
    v_fmac_f32 v164, v165, v163
    v_cvt_pk_bf16_f32 v164, v164, v164
    v_and_b32 v164, 0xffff0000, v164
    v_mul_f32 v164, v164, v161
    v_cvt_pk_bf16_f32 v33, v164, v164
    v_cndmask_b32_e64 v160, v34, v42, s[56:57]
    v_cndmask_b32_e64 v161, v42, v34, s[56:57]
    v_cvt_pk_bf16_f32 v160, v160, v161
    v_and_b32 v161, 0xffff0000, v160
    v_lshlrev_b32 v160, 16, v160
    v_mul_f32 v162, s48, v160
    v_exp_f32 v162, -v162
    s_nop 0
    v_add_f32 v162, 1.0, v162
    v_rcp_f32 v163, v162
    s_nop 0
    v_mul_f32 v164, v160, v163
    v_fma_f32 v165, -v164, v162, v160
    v_fmac_f32 v164, v165, v163
    v_cvt_pk_bf16_f32 v164, v164, v164
    v_and_b32 v164, 0xffff0000, v164
    v_mul_f32 v164, v164, v161
    v_cvt_pk_bf16_f32 v34, v164, v164
    v_cndmask_b32_e64 v160, v35, v43, s[56:57]
    v_cndmask_b32_e64 v161, v43, v35, s[56:57]
    v_cvt_pk_bf16_f32 v160, v160, v161
    v_and_b32 v161, 0xffff0000, v160
    v_lshlrev_b32 v160, 16, v160
    v_mul_f32 v162, s48, v160
    v_exp_f32 v162, -v162
    s_nop 0
    v_add_f32 v162, 1.0, v162
    v_rcp_f32 v163, v162
    s_nop 0
    v_mul_f32 v164, v160, v163
    v_fma_f32 v165, -v164, v162, v160
    v_fmac_f32 v164, v165, v163
    v_cvt_pk_bf16_f32 v164, v164, v164
    v_and_b32 v164, 0xffff0000, v164
    v_mul_f32 v164, v164, v161
    v_cvt_pk_bf16_f32 v35, v164, v164
    v_cndmask_b32_e64 v160, v36, v44, s[56:57]
    v_cndmask_b32_e64 v161, v44, v36, s[56:57]
    v_cvt_pk_bf16_f32 v160, v160, v161
    v_and_b32 v161, 0xffff0000, v160
    v_lshlrev_b32 v160, 16, v160
    v_mul_f32 v162, s48, v160
    v_exp_f32 v162, -v162
    s_nop 0
    v_add_f32 v162, 1.0, v162
    v_rcp_f32 v163, v162
    s_nop 0
    v_mul_f32 v164, v160, v163
    v_fma_f32 v165, -v164, v162, v160
    v_fmac_f32 v164, v165, v163
    v_cvt_pk_bf16_f32 v164, v164, v164
    v_and_b32 v164, 0xffff0000, v164
    v_mul_f32 v164, v164, v161
    v_cvt_pk_bf16_f32 v36, v164, v164
    v_cndmask_b32_e64 v160, v37, v45, s[56:57]
    v_cndmask_b32_e64 v161, v45, v37, s[56:57]
    v_cvt_pk_bf16_f32 v160, v160, v161
    v_and_b32 v161, 0xffff0000, v160
    v_lshlrev_b32 v160, 16, v160
    v_mul_f32 v162, s48, v160
    v_exp_f32 v162, -v162
    s_nop 0
    v_add_f32 v162, 1.0, v162
    v_rcp_f32 v163, v162
    s_nop 0
    v_mul_f32 v164, v160, v163
    v_fma_f32 v165, -v164, v162, v160
    v_fmac_f32 v164, v165, v163
    v_cvt_pk_bf16_f32 v164, v164, v164
    v_and_b32 v164, 0xffff0000, v164
    v_mul_f32 v164, v164, v161
    v_cvt_pk_bf16_f32 v37, v164, v164
    s_mul_i32 s28, s58, 110592
    s_mul_i32 s29, s59, 384
    s_add_u32 s28, s28, s29
    s_mul_i32 s29, s36, 36864
    s_add_u32 s28, s28, s29
    s_add_u32 s20, s20, s28
    s_addc_u32 s21, s21, 0
    s_add_u32 s62, s58, 32
    v_lshrrev_b32 v9, 3, v1
    v_and_b32 v9, 3, v9
    s_movk_i32 s28, 10240
    v_mul_u32_u24 v9, s28, v9
    v_and_b32 v8, 7, v1
    v_lshl_add_u32 v9, v8, 4, v9
    s_mul_i32 s28, s59, 12
    s_lshl_b32 s29, s36, 2
    s_add_u32 s28, s28, s29
    s_mul_i32 s28, s28, 10240
    s_lshl_b32 s29, s62, 7
    s_add_u32 s28, s28, s29
    s_add_u32 s28, s28, 1048576
    v_add_u32 v9, s28, v9
    s_mul_i32 s28, s36, 3072
    s_add_u32 s28, s28, 148480
    v_add_u32 v8, s28, v18
    s_lshl_b32 s28, s36, 10
    s_add_u32 s28, s28, 148480
    v_add_u32 v19, s28, v18
    s_and_b32 s61, s101, 15
    s_mov_b32 s30, 0
L_spin_29:
    ds_read_b32 v160, v10 offset:20
    s_waitcnt lgkmcnt(0)
    v_readfirstlane_b32 s29, v160
    s_nop 0
    s_cmp_ge_u32 s29, 8
    s_cbranch_scc1 L_spind_30
    s_add_u32 s30, s30, 1
    s_cmp_lt_u32 s30, 1048576
    s_cbranch_scc1 L_spin_29
L_spind_30:
    s_setprio 3
    global_load_dwordx4 v[68:71], v4, s[20:21] offset:0
    global_load_dwordx4 v[72:75], v4, s[20:21] offset:128
    global_load_dwordx4 v[76:79], v4, s[20:21] offset:256
    s_add_u32 s20, s20, 9216
    s_addc_u32 s21, s21, 0
    global_load_dwordx4 v[80:83], v4, s[20:21] offset:0
    global_load_dwordx4 v[84:87], v4, s[20:21] offset:128
    global_load_dwordx4 v[88:91], v4, s[20:21] offset:256
    s_add_u32 s20, s20, 9216
    s_addc_u32 s21, s21, 0
    global_load_dwordx4 v[92:95], v4, s[20:21] offset:0
    global_load_dwordx4 v[96:99], v4, s[20:21] offset:128
    global_load_dwordx4 v[100:103], v4, s[20:21] offset:256
    s_add_u32 s20, s20, 9216
    s_addc_u32 s21, s21, 0
    global_load_dwordx4 v[104:107], v4, s[20:21] offset:0
    global_load_dwordx4 v[108:111], v4, s[20:21] offset:128
    global_load_dwordx4 v[112:115], v4, s[20:21] offset:256
    s_waitcnt vmcnt(0)
    v_cndmask_b32_e64 v148, v30, v34, s[52:53]
    v_cndmask_b32_e64 v150, v34, v30, s[52:53]
    v_and_b32 v140, v148, v12
    v_and_b32 v141, v148, v13
    v_mov_b32_dpp v149, v150 row_ror:8 row_mask:0xf bank_mask:0xf
    v_and_b32 v142, v148, v14
    v_and_b32 v143, v148, v15
    v_and_b32 v144, v149, v12
    v_and_b32 v145, v149, v13
    v_and_b32 v146, v149, v14
    v_and_b32 v147, v149, v15
    v_mfma_f32_16x16x32_bf16 v[116:119], v[68:71], v[140:143], 0
    v_cndmask_b32_e64 v148, v31, v35, s[52:53]
    v_cndmask_b32_e64 v150, v35, v31, s[52:53]
    v_mfma_f32_16x16x32_bf16 v[120:123], v[68:71], v[144:147], 0
    v_and_b32 v152, v148, v12
    v_and_b32 v153, v148, v13
    v_mfma_f32_16x16x32_bf16 v[124:127], v[72:75], v[140:143], 0
    v_mov_b32_dpp v149, v150 row_ror:8 row_mask:0xf bank_mask:0xf
    v_and_b32 v154, v148, v14
    v_mfma_f32_16x16x32_bf16 v[128:131], v[72:75], v[144:147], 0
    v_and_b32 v155, v148, v15
    v_and_b32 v156, v149, v12
    v_mfma_f32_16x16x32_bf16 v[132:135], v[76:79], v[140:143], 0
    v_and_b32 v157, v149, v13
    v_and_b32 v158, v149, v14
    v_mfma_f32_16x16x32_bf16 v[136:139], v[76:79], v[144:147], 0
    v_and_b32 v159, v149, v15
    v_mfma_f32_16x16x32_bf16 v[116:119], v[80:83], v[152:155], v[116:119]
    v_cndmask_b32_e64 v148, v32, v36, s[52:53]
    v_cndmask_b32_e64 v150, v36, v32, s[52:53]
    v_mfma_f32_16x16x32_bf16 v[120:123], v[80:83], v[156:159], v[120:123]
    v_and_b32 v140, v148, v12
    v_and_b32 v141, v148, v13
    v_mfma_f32_16x16x32_bf16 v[124:127], v[84:87], v[152:155], v[124:127]
    v_mov_b32_dpp v149, v150 row_ror:8 row_mask:0xf bank_mask:0xf
    v_and_b32 v142, v148, v14
    v_mfma_f32_16x16x32_bf16 v[128:131], v[84:87], v[156:159], v[128:131]
    v_and_b32 v143, v148, v15
    v_and_b32 v144, v149, v12
    v_mfma_f32_16x16x32_bf16 v[132:135], v[88:91], v[152:155], v[132:135]
    v_and_b32 v145, v149, v13
    v_and_b32 v146, v149, v14
    v_mfma_f32_16x16x32_bf16 v[136:139], v[88:91], v[156:159], v[136:139]
    v_and_b32 v147, v149, v15
    v_mfma_f32_16x16x32_bf16 v[116:119], v[92:95], v[140:143], v[116:119]
    v_cndmask_b32_e64 v148, v33, v37, s[52:53]
    v_cndmask_b32_e64 v150, v37, v33, s[52:53]
    v_mfma_f32_16x16x32_bf16 v[120:123], v[92:95], v[144:147], v[120:123]
    v_and_b32 v152, v148, v12
    v_and_b32 v153, v148, v13
    v_mfma_f32_16x16x32_bf16 v[124:127], v[96:99], v[140:143], v[124:127]
    v_mov_b32_dpp v149, v150 row_ror:8 row_mask:0xf bank_mask:0xf
    v_and_b32 v154, v148, v14
    v_mfma_f32_16x16x32_bf16 v[128:131], v[96:99], v[144:147], v[128:131]
    v_and_b32 v155, v148, v15
    v_and_b32 v156, v149, v12
    v_mfma_f32_16x16x32_bf16 v[132:135], v[100:103], v[140:143], v[132:135]
    v_and_b32 v157, v149, v13
    v_and_b32 v158, v149, v14
    v_mfma_f32_16x16x32_bf16 v[136:139], v[100:103], v[144:147], v[136:139]
    v_and_b32 v159, v149, v15
    v_mfma_f32_16x16x32_bf16 v[116:119], v[104:107], v[152:155], v[116:119]
    s_nop 0
    v_mfma_f32_16x16x32_bf16 v[120:123], v[104:107], v[156:159], v[120:123]
    v_mfma_f32_16x16x32_bf16 v[124:127], v[108:111], v[152:155], v[124:127]
    v_mfma_f32_16x16x32_bf16 v[128:131], v[108:111], v[156:159], v[128:131]
    v_mfma_f32_16x16x32_bf16 v[132:135], v[112:115], v[152:155], v[132:135]
    v_mfma_f32_16x16x32_bf16 v[136:139], v[112:115], v[156:159], v[136:139]
    s_nop 3
    v_cndmask_b32_e64 v116, v120, v116, s[50:51]
    v_cndmask_b32_e64 v117, v121, v117, s[50:51]
    v_cndmask_b32_e64 v118, v122, v118, s[50:51]
    v_cndmask_b32_e64 v119, v123, v119, s[50:51]
    ds_write_b128 v8, v[116:119] offset:0
    v_cndmask_b32_e64 v124, v128, v124, s[50:51]
    v_cndmask_b32_e64 v125, v129, v125, s[50:51]
    v_cndmask_b32_e64 v126, v130, v126, s[50:51]
    v_cndmask_b32_e64 v127, v131, v127, s[50:51]
    ds_write_b128 v8, v[124:127] offset:1024
    v_cndmask_b32_e64 v132, v136, v132, s[50:51]
    v_cndmask_b32_e64 v133, v137, v133, s[50:51]
    v_cndmask_b32_e64 v134, v138, v134, s[50:51]
    v_cndmask_b32_e64 v135, v139, v135, s[50:51]
    ds_write_b128 v8, v[132:135] offset:2048
    s_mov_b64 exec, 1
    ds_add_u32 v10, v11 offset:28
    s_mov_b64 exec, -1
    s_mov_b32 s30, 0
L_spin_31:
    ds_read_b32 v160, v10 offset:28
    s_waitcnt lgkmcnt(0)
    v_readfirstlane_b32 s29, v160
    s_nop 0
    s_cmp_ge_u32 s29, 3
    s_cbranch_scc1 L_spind_32
    s_add_u32 s30, s30, 1
    s_cmp_lt_u32 s30, 1048576
    s_cbranch_scc1 L_spin_31
L_spind_32:
    ds_read_b128 v[68:71], v19 offset:0
    ds_read_b128 v[72:75], v19 offset:3072
    ds_read_b128 v[76:79], v19 offset:6144
    s_waitcnt lgkmcnt(1)
    v_pk_add_f32 v[68:69], v[68:69], v[72:73]
    v_pk_add_f32 v[70:71], v[70:71], v[74:75]
    s_waitcnt lgkmcnt(0)
    v_pk_add_f32 v[68:69], v[68:69], v[76:77]
    v_pk_add_f32 v[70:71], v[70:71], v[78:79]
    v_mov_b32 v72, v68
    v_mov_b32 v73, v69
    v_mov_b32 v74, v70
    v_mov_b32 v75, v71
    v_permlane32_swap_b32 v68, v72
    v_permlane32_swap_b32 v69, v73
    v_permlane32_swap_b32 v70, v74
    v_permlane32_swap_b32 v71, v75
    v_pk_add_f32 v[68:69], v[68:69], v[72:73]
    v_pk_add_f32 v[70:71], v[70:71], v[74:75]
    v_perm_b32 v68, v68, v17, s40
    v_perm_b32 v69, v69, v17, s41
    v_perm_b32 v70, v70, v17, s42
    v_perm_b32 v71, v71, v17, s43
    s_mov_b32 exec_lo, 0xffffffff
    s_mov_b32 exec_hi, 0x0
    global_store_dwordx4 v9, v[68:71], s[26:27] sc1
    s_mov_b64 exec, -1
    s_branch L_wts_done
L_final:
    s_cmp_ge_u32 s101, 36
    s_cbranch_scc1 L_wts_done
    s_mul_i32 s28, s101, 10240
    s_add_u32 s28, s28, 1048576
    v_add_u32 v6, s28, v18
    v_add_u32 v7, 4096, v6
    v_add_u32 v8, 8192, v6
    s_and_b32 s28, s101, 1
    s_mul_i32 s28, s28, 576
    s_lshr_b32 s29, s101, 1
    s_lshl_b32 s29, s29, 5
    s_add_u32 s28, s28, s29
    v_and_b32 v9, 31, v1
    v_add_u32 v9, s28, v9
    v_lshlrev_b32 v9, 1, v9
    global_load_ushort v19, v9, s[4:5]
    s_mov_b32 s30, 0
L_spin_33:
    ds_read_b32 v160, v10 offset:20
    s_waitcnt lgkmcnt(0)
    v_readfirstlane_b32 s29, v160
    s_nop 0
    s_cmp_ge_u32 s29, 8
    s_cbranch_scc1 L_spind_34
    s_add_u32 s30, s30, 1
    s_cmp_lt_u32 s30, 1048576
    s_cbranch_scc1 L_spin_33
L_spind_34:
    s_mov_b32 s30, 0
L_poll_35:
    global_load_dwordx4 v[68:71], v7, s[26:27] offset:0 sc1
    global_load_dwordx4 v[72:75], v7, s[26:27] offset:1024 sc1
    global_load_dwordx4 v[76:79], v7, s[26:27] offset:2048 sc1
    global_load_dwordx4 v[80:83], v7, s[26:27] offset:3072 sc1
    global_load_dwordx4 v[84:87], v8, s[26:27] offset:0 sc1
    global_load_dwordx4 v[88:91], v8, s[26:27] offset:1024 sc1
    s_waitcnt vmcnt(0)
    v_perm_b32 v161, v69, v68, s44
    v_perm_b32 v162, v71, v70, s45
    v_bitop3_b32 v160, v161, v162, v17 bitop3:0x56
    v_perm_b32 v161, v73, v72, s44
    v_perm_b32 v162, v75, v74, s45
    v_bitop3_b32 v161, v161, v162, v17 bitop3:0x56
    v_or_b32 v160, v160, v161
    v_perm_b32 v161, v77, v76, s44
    v_perm_b32 v162, v79, v78, s45
    v_bitop3_b32 v161, v161, v162, v17 bitop3:0x56
    v_or_b32 v160, v160, v161
    v_perm_b32 v161, v81, v80, s44
    v_perm_b32 v162, v83, v82, s45
    v_bitop3_b32 v161, v161, v162, v17 bitop3:0x56
    v_or_b32 v160, v160, v161
    v_perm_b32 v161, v85, v84, s44
    v_perm_b32 v162, v87, v86, s45
    v_bitop3_b32 v161, v161, v162, v17 bitop3:0x56
    v_or_b32 v160, v160, v161
    v_perm_b32 v161, v89, v88, s44
    v_perm_b32 v162, v91, v90, s45
    v_bitop3_b32 v161, v161, v162, v17 bitop3:0x56
    v_or_b32 v160, v160, v161
    v_cmp_ne_u32 vcc, 0, v160
    s_cbranch_vccz L_polld_36
    s_mov_b64 exec, vcc
    s_add_u32 s30, s30, 1
    s_cmp_lt_u32 s30, 32768
    s_cbranch_scc1 L_poll_35
L_polld_36:
    s_mov_b64 exec, -1
    global_load_dwordx4 v[92:95], v6, s[26:27] offset:0 sc1
    global_load_dwordx4 v[96:99], v6, s[26:27] offset:1024 sc1
    global_load_dwordx4 v[100:103], v6, s[26:27] offset:2048 sc1
    global_load_dwordx4 v[104:107], v6, s[26:27] offset:3072 sc1
    v_and_b32 v68, s46, v68
    v_and_b32 v69, s46, v69
    v_and_b32 v70, s46, v70
    v_and_b32 v71, s46, v71
    v_and_b32 v72, s46, v72
    v_and_b32 v73, s46, v73
    v_and_b32 v74, s46, v74
    v_and_b32 v75, s46, v75
    v_and_b32 v76, s46, v76
    v_and_b32 v77, s46, v77
    v_and_b32 v78, s46, v78
    v_and_b32 v79, s46, v79
    v_and_b32 v80, s46, v80
    v_and_b32 v81, s46, v81
    v_and_b32 v82, s46, v82
    v_and_b32 v83, s46, v83
    v_and_b32 v84, s46, v84
    v_and_b32 v85, s46, v85
    v_and_b32 v86, s46, v86
    v_and_b32 v87, s46, v87
    v_and_b32 v88, s46, v88
    v_and_b32 v89, s46, v89
    v_and_b32 v90, s46, v90
    v_and_b32 v91, s46, v91
    v_pk_add_f32 v[68:69], v[68:69], v[72:73]
    v_pk_add_f32 v[70:71], v[70:71], v[74:75]
    v_pk_add_f32 v[68:69], v[68:69], v[76:77]
    v_pk_add_f32 v[70:71], v[70:71], v[78:79]
    v_pk_add_f32 v[68:69], v[68:69], v[80:81]
    v_pk_add_f32 v[70:71], v[70:71], v[82:83]
    v_pk_add_f32 v[68:69], v[68:69], v[84:85]
    v_pk_add_f32 v[70:71], v[70:71], v[86:87]
    v_pk_add_f32 v[68:69], v[68:69], v[88:89]
    v_pk_add_f32 v[70:71], v[70:71], v[90:91]
    s_nop 0
    v_add_f32_dpp v68, v68, v68 row_ror:8 row_mask:0xf bank_mask:0xf
    v_add_f32_dpp v69, v69, v69 row_ror:8 row_mask:0xf bank_mask:0xf
    v_add_f32_dpp v70, v70, v70 row_ror:8 row_mask:0xf bank_mask:0xf
    v_add_f32_dpp v71, v71, v71 row_ror:8 row_mask:0xf bank_mask:0xf
    v_mov_b32 v72, v68
    v_mov_b32 v73, v69
    v_mov_b32 v74, v70
    v_mov_b32 v75, v71
    v_permlane16_swap_b32 v68, v72
    v_permlane16_swap_b32 v69, v73
    v_permlane16_swap_b32 v70, v74
    v_permlane16_swap_b32 v71, v75
    v_add_f32 v68, v68, v72
    v_add_f32 v69, v69, v73
    v_add_f32 v70, v70, v74
    v_add_f32 v71, v71, v75
    v_mov_b32 v72, v68
    v_mov_b32 v73, v69
    v_mov_b32 v74, v70
    v_mov_b32 v75, v71
    v_permlane32_swap_b32 v68, v72
    v_permlane32_swap_b32 v69, v73
    v_permlane32_swap_b32 v70, v74
    v_permlane32_swap_b32 v71, v75
    v_add_f32 v68, v68, v72
    v_add_f32 v69, v69, v73
    v_add_f32 v70, v70, v74
    v_add_f32 v71, v71, v75
    v_cndmask_b32_e64 v68, v68, v69, s[52:53]
    v_cndmask_b32_e64 v70, v70, v71, s[52:53]
    v_cndmask_b32_e64 v68, v68, v70, s[54:55]
    s_mov_b32 s48, 0x3fb8aa3b
    v_cvt_pk_bf16_f32 v68, v68, v68
    v_and_b32 v68, 0xffff0000, v68
    v_mul_f32 v162, s48, v68
    v_exp_f32 v162, -v162
    s_nop 0
    v_add_f32 v162, 1.0, v162
    v_rcp_f32 v163, v162
    s_nop 0
    v_mul_f32 v164, v68, v163
    v_fma_f32 v165, -v164, v162, v68
    v_fmac_f32 v164, v165, v163
    v_cvt_pk_bf16_f32 v164, v164, v164
    v_and_b32 v20, 0xffff0000, v164
    v_lshlrev_b32 v19, 16, v19
    s_mov_b32 s30, 0
L_f2_37:
    global_load_dwordx4 v[108:111], v6, s[26:27] offset:0 sc1
    global_load_dwordx4 v[112:115], v6, s[26:27] offset:1024 sc1
    global_load_dwordx4 v[116:119], v6, s[26:27] offset:2048 sc1
    global_load_dwordx4 v[120:123], v6, s[26:27] offset:3072 sc1
    s_waitcnt vmcnt(4)
    v_perm_b32 v161, v93, v92, s44
    v_perm_b32 v162, v95, v94, s45
    v_bitop3_b32 v160, v161, v162, v17 bitop3:0x56
    v_perm_b32 v161, v97, v96, s44
    v_perm_b32 v162, v99, v98, s45
    v_bitop3_b32 v161, v161, v162, v17 bitop3:0x56
    v_or_b32 v160, v160, v161
    v_perm_b32 v161, v101, v100, s44
    v_perm_b32 v162, v103, v102, s45
    v_bitop3_b32 v161, v161, v162, v17 bitop3:0x56
    v_or_b32 v160, v160, v161
    v_perm_b32 v161, v105, v104, s44
    v_perm_b32 v162, v107, v106, s45
    v_bitop3_b32 v161, v161, v162, v17 bitop3:0x56
    v_or_b32 v160, v160, v161
    v_cmp_ne_u32 vcc, 0, v160
    s_cbranch_vccz L_f2a_38
    global_load_dwordx4 v[92:95], v6, s[26:27] offset:0 sc1
    global_load_dwordx4 v[96:99], v6, s[26:27] offset:1024 sc1
    global_load_dwordx4 v[100:103], v6, s[26:27] offset:2048 sc1
    global_load_dwordx4 v[104:107], v6, s[26:27] offset:3072 sc1
    s_waitcnt vmcnt(4)
    v_perm_b32 v161, v109, v108, s44
    v_perm_b32 v162, v111, v110, s45
    v_bitop3_b32 v160, v161, v162, v17 bitop3:0x56
    v_perm_b32 v161, v113, v112, s44
    v_perm_b32 v162, v115, v114, s45
    v_bitop3_b32 v161, v161, v162, v17 bitop3:0x56
    v_or_b32 v160, v160, v161
    v_perm_b32 v161, v117, v116, s44
    v_perm_b32 v162, v119, v118, s45
    v_bitop3_b32 v161, v161, v162, v17 bitop3:0x56
    v_or_b32 v160, v160, v161
    v_perm_b32 v161, v121, v120, s44
    v_perm_b32 v162, v123, v122, s45
    v_bitop3_b32 v161, v161, v162, v17 bitop3:0x56
    v_or_b32 v160, v160, v161
    v_cmp_ne_u32 vcc, 0, v160
    s_cbranch_vccz L_f2b_39
    s_add_u32 s30, s30, 1
    s_cmp_lt_u32 s30, 32768
    s_cbranch_scc1 L_f2_37
L_f2b_39:
    v_and_b32 v108, s46, v108
    v_and_b32 v109, s46, v109
    v_and_b32 v110, s46, v110
    v_and_b32 v111, s46, v111
    v_and_b32 v112, s46, v112
    v_and_b32 v113, s46, v113
    v_and_b32 v114, s46, v114
    v_and_b32 v115, s46, v115
    v_and_b32 v116, s46, v116
    v_and_b32 v117, s46, v117
    v_and_b32 v118, s46, v118
    v_and_b32 v119, s46, v119
    v_and_b32 v120, s46, v120
    v_and_b32 v121, s46, v121
    v_and_b32 v122, s46, v122
    v_and_b32 v123, s46, v123
    v_pk_add_f32 v[108:109], v[108:109], v[112:113]
    v_pk_add_f32 v[110:111], v[110:111], v[114:115]
    v_pk_add_f32 v[108:109], v[108:109], v[116:117]
    v_pk_add_f32 v[110:111], v[110:111], v[118:119]
    v_pk_add_f32 v[108:109], v[108:109], v[120:121]
    v_pk_add_f32 v[110:111], v[110:111], v[122:123]
    s_nop 0
    v_add_f32_dpp v108, v108, v108 row_ror:8 row_mask:0xf bank_mask:0xf
    v_add_f32_dpp v109, v109, v109 row_ror:8 row_mask:0xf bank_mask:0xf
    v_add_f32_dpp v110, v110, v110 row_ror:8 row_mask:0xf bank_mask:0xf
    v_add_f32_dpp v111, v111, v111 row_ror:8 row_mask:0xf bank_mask:0xf
    v_mov_b32 v112, v108
    v_mov_b32 v113, v109
    v_mov_b32 v114, v110
    v_mov_b32 v115, v111
    v_permlane16_swap_b32 v108, v112
    v_permlane16_swap_b32 v109, v113
    v_permlane16_swap_b32 v110, v114
    v_permlane16_swap_b32 v111, v115
    v_add_f32 v108, v108, v112
    v_add_f32 v109, v109, v113
    v_add_f32 v110, v110, v114
    v_add_f32 v111, v111, v115
    v_mov_b32 v112, v108
    v_mov_b32 v113, v109
    v_mov_b32 v114, v110
    v_mov_b32 v115, v111
    v_permlane32_swap_b32 v108, v112
    v_permlane32_swap_b32 v109, v113
    v_permlane32_swap_b32 v110, v114
    v_permlane32_swap_b32 v111, v115
    v_add_f32 v108, v108, v112
    v_add_f32 v109, v109, v113
    v_add_f32 v110, v110, v114
    v_add_f32 v111, v111, v115
    v_cndmask_b32_e64 v108, v108, v109, s[52:53]
    v_cndmask_b32_e64 v110, v110, v111, s[52:53]
    v_cndmask_b32_e64 v108, v108, v110, s[54:55]
    v_mov_b32 v166, v108
    s_branch L_f2x_40
L_f2a_38:
    v_and_b32 v92, s46, v92
    v_and_b32 v93, s46, v93
    v_and_b32 v94, s46, v94
    v_and_b32 v95, s46, v95
    v_and_b32 v96, s46, v96
    v_and_b32 v97, s46, v97
    v_and_b32 v98, s46, v98
    v_and_b32 v99, s46, v99
    v_and_b32 v100, s46, v100
    v_and_b32 v101, s46, v101
    v_and_b32 v102, s46, v102
    v_and_b32 v103, s46, v103
    v_and_b32 v104, s46, v104
    v_and_b32 v105, s46, v105
    v_and_b32 v106, s46, v106
    v_and_b32 v107, s46, v107
    v_pk_add_f32 v[92:93], v[92:93], v[96:97]
    v_pk_add_f32 v[94:95], v[94:95], v[98:99]
    v_pk_add_f32 v[92:93], v[92:93], v[100:101]
    v_pk_add_f32 v[94:95], v[94:95], v[102:103]
    v_pk_add_f32 v[92:93], v[92:93], v[104:105]
    v_pk_add_f32 v[94:95], v[94:95], v[106:107]
    s_nop 0
    v_add_f32_dpp v92, v92, v92 row_ror:8 row_mask:0xf bank_mask:0xf
    v_add_f32_dpp v93, v93, v93 row_ror:8 row_mask:0xf bank_mask:0xf
    v_add_f32_dpp v94, v94, v94 row_ror:8 row_mask:0xf bank_mask:0xf
    v_add_f32_dpp v95, v95, v95 row_ror:8 row_mask:0xf bank_mask:0xf
    v_mov_b32 v96, v92
    v_mov_b32 v97, v93
    v_mov_b32 v98, v94
    v_mov_b32 v99, v95
    v_permlane16_swap_b32 v92, v96
    v_permlane16_swap_b32 v93, v97
    v_permlane16_swap_b32 v94, v98
    v_permlane16_swap_b32 v95, v99
    v_add_f32 v92, v92, v96
    v_add_f32 v93, v93, v97
    v_add_f32 v94, v94, v98
    v_add_f32 v95, v95, v99
    v_mov_b32 v96, v92
    v_mov_b32 v97, v93
    v_mov_b32 v98, v94
    v_mov_b32 v99, v95
    v_permlane32_swap_b32 v92, v96
    v_permlane32_swap_b32 v93, v97
    v_permlane32_swap_b32 v94, v98
    v_permlane32_swap_b32 v95, v99
    v_add_f32 v92, v92, v96
    v_add_f32 v93, v93, v97
    v_add_f32 v94, v94, v98
    v_add_f32 v95, v95, v99
    v_cndmask_b32_e64 v92, v92, v93, s[52:53]
    v_cndmask_b32_e64 v94, v94, v95, s[52:53]
    v_cndmask_b32_e64 v92, v92, v94, s[54:55]
    v_mov_b32 v166, v92
L_f2x_40:
    v_cvt_pk_bf16_f32 v166, v166, v166
    v_and_b32 v166, 0xffff0000, v166
    v_mul_f32 v166, v166, v20
    v_cvt_pk_bf16_f32 v166, v166, v166
    v_and_b32 v166, 0xffff0000, v166
    v_add_f32 v166, v19, v166
    v_cvt_pk_bf16_f32 v166, v166, v166
    s_mov_b32 exec_lo, 0xffffffff
    s_mov_b32 exec_hi, 0x0
    global_store_short v9, v166, s[22:23]
    s_mov_b64 exec, -1
    s_cmp_lg_u32 s101, 0
    s_cbranch_scc1 L_wts_done
    v_mov_b32 v160, 0
    s_mov_b64 exec, 1
    global_store_dword v160, v16, s[26:27]
    s_mov_b64 exec, -1
L_wts_done:
L_end:
    s_endpgm
.p2align 6
.type L_roles,@object
L_roles:
    .long 0xa0000000, 0xa1010101, 0xa2020202, 0xa3030303, 0xa4040404, 0xa5050505, 0xa6060606, 0xa7070707
    .long 0xa8080808, 0xa9090909, 0xaa0a0a0a, 0xab0b0b0b, 0xac0c100c, 0xad0d110d, 0xae0e120e, 0xaf0f130f
    .long 0xb0101410, 0xb1111511, 0xb2121612, 0xb3131713, 0xb4141814, 0xb5151915, 0xb6161a16, 0xb7171b17
    .long 0xb8181c18, 0xb9191d19, 0xba1a1e1a, 0xbb1b1f1b, 0xbc1c201c, 0xbd1d211d, 0xbe1e221e, 0xbf1f231f
    .long 0xc0202420, 0xc1212521, 0xc2222622, 0xc3232723, 0xc4242824, 0xc5252925, 0xc6262a26, 0xc7272b27
    .long 0xc8283028, 0xc9293129, 0xca2a322a, 0xcb2b332b, 0xcc2c342c, 0xcd2d352d, 0xce2e362e, 0xcf2f372f
    .long 0xd0303830, 0xd1313931, 0xd2323a32, 0xd3333b33, 0xd4343c34, 0xd5353d35, 0xd6363e36, 0xd7373f37
    .long 0x384038, 0x1394139, 0x23a423a, 0x33b433b, 0x43c443c, 0x53d453d, 0x63e463e, 0x73f473f
    .long 0x8404840, 0x9414941, 0xa424a42, 0xb434b43, 0xc445044, 0xd455145, 0xe465246, 0xf475347
    .long 0x10485448, 0x11495549, 0x124a564a, 0x134b574b, 0x144c584c, 0x154d594d, 0x164e5a4e, 0x174f5b4f
    .long 0x18505c50, 0x19515d51, 0x1a525e52, 0x1b535f53, 0x1c546054, 0x1d556155, 0x1e566256, 0x1f576357
    .long 0x20586458, 0x21596559, 0x225a665a, 0x235b675b, 0x245c685c, 0x255d695d, 0x265e6a5e, 0x275f6b5f
    .long 0x28607060, 0x29617161, 0x2a627262, 0x2b637363, 0x2c647464, 0x2d657565, 0x2e667666, 0x2f677767
    .long 0x30687868, 0x31697969, 0x326a7a6a, 0x336b7b6b, 0x346c7c6c, 0x356d7d6d, 0x366e7e6e, 0x376f7f6f
    .long 0x38708070, 0x39718171, 0x3a728272, 0x3b738373, 0x3c748474, 0x3d758575, 0x3e768676, 0x3f778777
    .long 0x40788878, 0x41798979, 0x427a8a7a, 0x437b8b7b, 0x447c907c, 0x457d917d, 0x467e927e, 0x477f937f
    .long 0x48809480, 0x49819581, 0x4a829682, 0x4b839783, 0x4c849884, 0x4d859985, 0x4e869a86, 0x4f879b87
    .long 0x50889c88, 0x51899d89, 0x528a9e8a, 0x538b9f8b, 0x548ca08c, 0x558da18d, 0x568ea28e, 0x578fa38f
    .long 0x5890a490, 0x5991a591, 0x5a92a692, 0x5b93a793, 0x5c94a894, 0x5d95a995, 0x5e96aa96, 0x5f97ab97
    .long 0x6098b098, 0x6199b199, 0x629ab29a, 0x639bb39b, 0x649cb49c, 0x659db59d, 0x669eb69e, 0x679fb79f
    .long 0x68a0b8a0, 0x69a1b9a1, 0x6aa2baa2, 0x6ba3bba3, 0x6ca4bca4, 0x6da5bda5, 0x6ea6bea6, 0x6fa7bfa7
    .long 0x70a8c0a8, 0x71a9c1a9, 0x72aac2aa, 0x73abc3ab, 0x74acc4ac, 0x75adc5ad, 0x76aec6ae, 0x77afc7af
    .long 0x78b0c8b0, 0x79b1c9b1, 0x7ab2cab2, 0x7bb3cbb3, 0x7cb4d0b4, 0x7db5d1b5, 0x7eb6d2b6, 0x7fb7d3b7
    .long 0x80b8d4b8, 0x81b9d5b9, 0x82bad6ba, 0x83bbd7bb, 0x84bcd8bc, 0x85bdd9bd, 0x86bedabe, 0x87bfdbbf
    .long 0x88c0dcc0, 0x89c1ddc1, 0x8ac2dec2, 0x8bc3dfc3, 0x8cc4e0c4, 0x8dc5e1c5, 0x8ec6e2c6, 0x8fc7e3c7
    .long 0x90c8e4c8, 0x92c9e5c9, 0x94cae6ca, 0x96cbe7cb, 0x98cce8cc, 0x9acde9cd, 0x9cceeace, 0x9ecfebcf
    .long 0x91d0f0d0, 0x93d1f1d1, 0x95d2f2d2, 0x97d3f3d3, 0x99d4f4d4, 0x9bd5f5d5, 0x9dd6f6d6, 0x9fd7f7d7
    .long 0xd8d80cd8, 0xd9d90dd9, 0xdada0eda, 0xdbdb0fdb, 0xdcdc2cdc, 0xdddd2ddd, 0xdede2ede, 0xdfdf2fdf
    .long 0xe0e04ce0, 0xe1e14de1, 0xe2e24ee2, 0xe3e34fe3, 0xe4e46ce4, 0xe5e56de5, 0xe6e66ee6, 0xe7e76fe7
    .long 0xe8e88ce8, 0xe9e98de9, 0xeaea8eea, 0xebeb8feb, 0xececacec, 0xededaded, 0xeeeeaeee, 0xefefafef
    .long 0xf0f0ccf0, 0xf1f1cdf1, 0xf2f2cef2, 0xf3f3cff3, 0xf4f4ecf4, 0xf5f5edf5, 0xf6f6eef6, 0xf7f7eff7
    .long 0xf8f8f8f8, 0xf9f9f9f9, 0xfafafafa, 0xfbfbfbfb, 0xfcfcfcfc, 0xfdfdfdfd, 0xfefefefe, 0xffffffff
.size L_roles, 1024
.section .rodata,"a"
.p2align 6
.amdhsa_kernel recurrent_scan__sliding_block_cached__glu_gated_swiglu__decode_kernel
  .amdhsa_next_free_vgpr 168
  .amdhsa_next_free_sgpr 102
  .amdhsa_accum_offset 168
  .amdhsa_group_segment_fixed_size 0
  .amdhsa_kernarg_size 96
  .amdhsa_user_sgpr_count 2
  .amdhsa_user_sgpr_kernarg_segment_ptr 1
  .amdhsa_system_sgpr_workgroup_id_x 1
  .amdhsa_float_denorm_mode_32 3
.end_amdhsa_kernel
```
